```python
import torch

def _softmax(x, axis=-1):
    return torch.softmax(x, dim=axis)
def _gelu(x):
    return torch.nn.functional.gelu(x, approximate="tanh")
def _silu(x):
    return torch.nn.functional.silu(x)
def _sigmoid(x):
    return torch.sigmoid(x)
def _layernorm(x, axis=-1, eps=1e-5):
    m = x.mean(dim=axis, keepdim=True)
    v = x.var(dim=axis, keepdim=True, unbiased=False)
    return (x - m) / torch.sqrt(v + eps)
def _scatter_add(tgt, idx, src, axis=0):
    return tgt.clone().index_add_(axis, idx, src)
def _segment_sum(src, seg, n):
    out = torch.zeros((n,) + src.shape[1:], dtype=src.dtype)
    return out.index_add_(0, seg, src)
def _pad(x, pw):
    flat = tuple(v for pair in reversed(pw) for v in pair)
    return torch.nn.functional.pad(x, flat)

kernel_name = 'parallel_sum__ssm_conv_s4__dense_activation_relu__prompt'

def setup_inputs():

    _w = (lambda a: (lambda t: t.to(torch.bfloat16) if t.is_floating_point() else t)(torch.as_tensor(a)))
    def _A_setup():
        B, L, D, N = 1, 2048, 576, 128
        A_re = -(lambda _x: torch.exp(torch.as_tensor(_x)))((lambda *s: torch.randn(*s, dtype=torch.bfloat16) * 3.2)(D, N))
        A_im = torch.pi * (lambda *s: torch.randn(*s, dtype=torch.bfloat16) * 0.2)(D, N)
        B_re = (lambda *s: torch.randn(*s, dtype=torch.bfloat16) * 0.4)(D, N)
        B_im = (lambda *s: torch.randn(*s, dtype=torch.bfloat16) * 0.4)(D, N)
        C_re = (lambda *s: torch.randn(*s, dtype=torch.bfloat16) * 0.4)(D, N)
        C_im = (lambda *s: torch.randn(*s, dtype=torch.bfloat16) * 0.4)(D, N)
        log_dt = (lambda *s: torch.randn(*s, dtype=torch.bfloat16) * 0.2)(D) * 0.5 - 4.0
        Dskip = (lambda *s: torch.randn(*s, dtype=torch.bfloat16) * 0.4)(D)
        return {
            "u": _w((lambda *s: torch.randn(*s, dtype=torch.bfloat16) * 0.05)(B, L, D)),
            "A_re": _w(A_re),
            "A_im": _w(A_im),
            "B_re": _w(B_re),
            "B_im": _w(B_im),
            "C_re": _w(C_re),
            "C_im": _w(C_im),
            "log_dt": _w(log_dt),
            "Dskip": _w(Dskip),
        }
    _A_in = _A_setup()

    def _B_setup():
        B, S, D, Dff = 1, 2048, 576, 4608
        return {
            "x": _w((lambda *s: torch.randn(*s, dtype=torch.bfloat16) * 0.05)(B, S, D)),
            "w1": _w((lambda *s: torch.randn(*s, dtype=torch.bfloat16) * 0.05)(D, Dff)),
            "w2": _w((lambda *s: torch.randn(*s, dtype=torch.bfloat16) * 0.05)(Dff, D)),
        }
    _B_in = _B_setup()

    return {
        "A_u": _A_in["u"],
        "A_A_re": _A_in["A_re"],
        "A_A_im": _A_in["A_im"],
        "A_B_re": _A_in["B_re"],
        "A_B_im": _A_in["B_im"],
        "A_C_re": _A_in["C_re"],
        "A_C_im": _A_in["C_im"],
        "A_log_dt": _A_in["log_dt"],
        "A_Dskip": _A_in["Dskip"],
        "B_x": _B_in["x"],
        "B_w1": _B_in["w1"],
        "B_w2": _B_in["w2"],
    }

def reference(A_u, A_A_re, A_A_im, A_B_re, A_B_im, A_C_re, A_C_im, A_log_dt, A_Dskip, B_x, B_w1, B_w2):
    def _A_ref(u, A_re, A_im, B_re, B_im, C_re, C_im, log_dt, Dskip):
        Bsz, L, D = u.shape
        dt = torch.exp(log_dt)[:, None]
        A = A_re + 1j * A_im
        Bc = B_re + 1j * B_im
        Cc = C_re + 1j * C_im
        logdA = dt * A
        dB = dt * Bc
        l = (lambda x, dt: x.to(dt))(torch.arange(L), A_re.dtype)
        P = torch.exp(logdA[:, :, None] * l[None, None, :])
        K = torch.einsum("dn,dnl,dn->dl", Cc, P, dB).real
        L2 = 2 * L
        Kp = _pad(K, ((0, 0), (0, L)))
        up = (lambda x, *d: x.permute(*d))(u, 0, 2, 1)
        up = _pad(up, ((0, 0), (0, 0), (0, L)))
        Kf = (lambda x, axes=(-2,-1): torch.fft.rfft2(x.float(), dim=axes))(Kp[:, None, :], axes=(-2, -1))
        Uf = (lambda x, axes=(-2,-1): torch.fft.rfft2(x.float(), dim=axes))(up[:, :, None, :], axes=(-2, -1))
        Yf = Uf * Kf[None, :, :, :]
        y = (lambda x, s, axes=(-2,-1): torch.fft.irfft2(x, s=s, dim=axes).to(torch.bfloat16))(Yf, (1, L2), axes=(-2, -1))[:, :, 0, :L]
        y = (lambda x, *d: x.permute(*d))(y, 0, 2, 1) + u * Dskip[None, None, :]
        return y

    def _B_ref(x, w1, w2):
        h = torch.einsum("bsd,df->bsf", x, w1)
        zero = torch.zeros_like(h)
        h = torch.maximum(h, zero)
        return torch.einsum("bsf,fd->bsd", h, w2)

    x = A_u
    xn = _layernorm(x, axis=-1)
    return x + _A_ref(xn, A_A_re, A_A_im, A_B_re, A_B_im, A_C_re, A_C_im, A_log_dt, A_Dskip) + _B_ref(xn, B_w1, B_w2)
```

```asm
; @launch grid=(256,1,1) block=(768,1,1) lds=163840
.amdgcn_target "amdgcn-amd-amdhsa--gfx950"
.text
.globl parallel_sum__ssm_conv_s4__dense_activation_relu__prompt_kernel
.p2align 8
.type parallel_sum__ssm_conv_s4__dense_activation_relu__prompt_kernel,@function
parallel_sum__ssm_conv_s4__dense_activation_relu__prompt_kernel:
    s_load_dwordx16 s[16:31], s[0:1], 0
    s_load_dwordx8 s[32:39], s[0:1], 64
    s_load_dwordx4 s[40:43], s[0:1], 96
    s_load_dwordx2 s[44:45], s[0:1], 112
    s_cmp_ge_u32 s2, 256
    s_cbranch_scc1 L_exitA
    v_lshrrev_b32 v1, 6, v0
    v_and_b32 v0, 63, v0
    v_readfirstlane_b32 s3, v1
    s_and_b32 s8, s2, 7
    s_lshr_b32 s9, s2, 3
    s_and_b32 s4, s3, 3
    s_lshr_b32 s5, s3, 2
    s_cmp_lt_u32 s9, 6
    s_cbranch_scc1 L_ssm
    s_cmp_eq_u32 s5, 1
    s_cbranch_scc1 L_lo
    s_setprio 3
L_lo:
    s_sub_u32 s9, s9, 6
    s_cmp_ge_u32 s9, 13
    s_cselect_b32 s10, 1, 0
    s_mul_i32 s11, s10, 13
    s_sub_u32 s72, s9, s11
    s_and_b32 s11, s8, 1
    s_mul_i32 s11, s11, 13
    s_add_u32 s46, s11, s72
    s_lshr_b32 s11, s8, 1
    s_lshl_b32 s11, s11, 1
    s_add_u32 s47, s11, s10
    s_mul_i32 s76, s72, 178
    s_lshr_b32 s76, s76, 8
    s_mov_b32 s77, 0
    s_mov_b32 s101, s76
    s_cmp_eq_u32 s5, 2
    s_cbranch_scc1 L_loader
    s_cmp_eq_u32 s5, 1
    s_cbranch_scc1 L_gE
    v_lshrrev_b32 v1, 3, v0
    v_and_b32 v3, 7, v0
    v_xor_b32 v2, v1, v3
    v_mul_u32_u24 v1, 1152, v1
    v_lshl_add_u32 v151, v2, 4, v1
    s_mul_i32 s12, s46, 91008
    s_mul_i32 s13, s4, 9216
    s_add_u32 s12, s12, s13
    s_lshl_b32 s13, s76, 7
    s_add_u32 s12, s12, s13
    s_lshl_b32 s13, s4, 10
    s_add_u32 s13, s13, 61440
    s_mov_b32 s14, s4
    s_mov_b32 s74, 36864
    s_mov_b32 s75, -55168
    s_mov_b32 s50, 2359296
    s_mov_b32 s51, 0x20000
    s_waitcnt lgkmcnt(0)
    s_mov_b32 s48, s16
    s_and_b32 s49, s17, 0xffff
    s_mov_b32 m0, s13
    s_cmp_eq_u32 s14, 9
    s_cselect_b32 exec_hi, 0x00ffffff, -1
    buffer_load_dwordx4 v151, s[48:51], s12 offen lds
    s_mov_b32 exec_hi, -1
    s_add_u32 s13, s13, 4096
    s_cmp_lt_u32 s14, 6
    s_cselect_b32 s15, s74, s75
    s_cselect_b32 s8, 4, -6
    s_subb_u32 s76, s76, -1
    s_add_u32 s12, s12, s15
    s_add_u32 s14, s14, s8
    s_cmp_eq_u32 s76, 9
    s_cselect_b32 s8, 1152, 0
    s_cselect_b32 s76, 0, s76
    s_sub_u32 s12, s12, s8
    s_mov_b32 m0, s13
    s_cmp_eq_u32 s14, 9
    s_cselect_b32 exec_hi, 0x00ffffff, -1
    buffer_load_dwordx4 v151, s[48:51], s12 offen lds
    s_mov_b32 exec_hi, -1
    s_add_u32 s13, s13, 4096
    s_cmp_lt_u32 s14, 6
    s_cselect_b32 s15, s74, s75
    s_cselect_b32 s8, 4, -6
    s_subb_u32 s76, s76, -1
    s_add_u32 s12, s12, s15
    s_add_u32 s14, s14, s8
    s_cmp_eq_u32 s76, 9
    s_cselect_b32 s8, 1152, 0
    s_cselect_b32 s76, 0, s76
    s_sub_u32 s12, s12, s8
    s_mov_b32 m0, s13
    s_cmp_eq_u32 s14, 9
    s_cselect_b32 exec_hi, 0x00ffffff, -1
    buffer_load_dwordx4 v151, s[48:51], s12 offen lds
    s_mov_b32 exec_hi, -1
    s_add_u32 s13, s13, 4096
    s_cmp_lt_u32 s14, 6
    s_cselect_b32 s15, s74, s75
    s_cselect_b32 s8, 4, -6
    s_subb_u32 s76, s76, -1
    s_add_u32 s12, s12, s15
    s_add_u32 s14, s14, s8
    s_cmp_eq_u32 s76, 9
    s_cselect_b32 s8, 1152, 0
    s_cselect_b32 s76, 0, s76
    s_sub_u32 s12, s12, s8
    s_barrier
    s_setprio 0
    s_mov_b32 s64, 0x3f803f80
    s_mov_b32 s65, 0x00003f80
    s_mov_b32 s66, 0x3f800000
    s_mov_b32 s60, s44
    s_and_b32 s61, s45, 0xffff
    s_mov_b32 s62, 268435456
    s_mov_b32 s63, 0x20000
    s_mul_i32 s8, s4, 18
    v_add_u32 v1, s8, v0
    v_lshrrev_b32 v2, 3, v1
    v_mul_u32_u24 v2, 10240, v2
    v_and_b32 v1, 7, v1
    v_lshl_add_u32 v1, v1, 4, v2
    v_add_u32 v1, 71552, v1
    v_mov_b32 v72, s64
    v_mov_b32 v73, s64
    v_mov_b32 v74, s64
    v_mov_b32 v75, s64
    s_mov_b64 exec, 0x3ffff
    ds_write_b128 v1, v[72:75]
    s_mov_b64 exec, -1
    v_lshrrev_b32 v6, 4, v0
    v_bfe_u32 v7, v0, 2, 2
    v_mul_u32_u24 v8, 24, v6
    v_add_lshl_u32 v8, v8, v7, 7
    v_and_b32 v9, 3, v0
    v_lshl_add_u32 v8, v9, 3, v8
    v_lshrrev_b32 v7, 1, v7
    v_and_b32 v9, 1, v6
    v_lshl_or_b32 v7, v9, 1, v7
    v_xor_b32 v9, s4, v7
    v_lshl_add_u32 v1, v9, 5, v8
    v_add_u32 v2, 1024, v1
    v_add_u32 v3, 2048, v1
    v_and_b32 v5, 15, v0
    v_and_b32 v7, 7, v5
    v_xor_b32 v7, v6, v7
    v_lshlrev_b32 v7, 4, v7
    v_lshl_add_u32 v7, v5, 7, v7
    v_add_u32 v10, 61440, v7
    v_xor_b32 v11, 64, v10
    v_add_u32 v11, 90112, v11
    s_mov_b32 m0, s13
    s_cmp_eq_u32 s14, 9
    s_cselect_b32 exec_hi, 0x00ffffff, -1
    buffer_load_dwordx4 v151, s[48:51], s12 offen lds
    s_mov_b32 exec_hi, -1
    s_add_u32 s13, s13, 4096
    s_cmp_lt_u32 s14, 6
    s_cselect_b32 s15, s74, s75
    s_cselect_b32 s8, 4, -6
    s_subb_u32 s76, s76, -1
    s_add_u32 s12, s12, s15
    s_add_u32 s14, s14, s8
    s_cmp_eq_u32 s76, 9
    s_cselect_b32 s8, 1152, 0
    s_cselect_b32 s76, 0, s76
    s_sub_u32 s12, s12, s8
    s_mov_b32 m0, s13
    s_cmp_eq_u32 s14, 9
    s_cselect_b32 exec_hi, 0x00ffffff, -1
    buffer_load_dwordx4 v151, s[48:51], s12 offen lds
    s_mov_b32 exec_hi, -1
    s_add_u32 s13, s13, 4096
    s_cmp_lt_u32 s14, 6
    s_cselect_b32 s15, s74, s75
    s_cselect_b32 s8, 4, -6
    s_subb_u32 s76, s76, -1
    s_add_u32 s12, s12, s15
    s_add_u32 s14, s14, s8
    s_cmp_eq_u32 s76, 9
    s_cselect_b32 s8, 1152, 0
    s_cselect_b32 s76, 0, s76
    s_sub_u32 s12, s12, s8
    s_waitcnt vmcnt(2)
    s_mov_b32 m0, s13
    s_cmp_eq_u32 s14, 9
    s_cselect_b32 exec_hi, 0x00ffffff, -1
    buffer_load_dwordx4 v151, s[48:51], s12 offen lds
    s_mov_b32 exec_hi, -1
    s_add_u32 s13, s13, 4096
    s_cmp_lt_u32 s14, 6
    s_cselect_b32 s15, s74, s75
    s_cselect_b32 s8, 4, -6
    s_subb_u32 s76, s76, -1
    s_add_u32 s12, s12, s15
    s_add_u32 s14, s14, s8
    s_cmp_eq_u32 s76, 9
    s_cselect_b32 s8, 1152, 0
    s_cselect_b32 s76, 0, s76
    s_sub_u32 s12, s12, s8
    s_mov_b32 m0, s13
    s_cmp_eq_u32 s14, 9
    s_cselect_b32 exec_hi, 0x00ffffff, -1
    buffer_load_dwordx4 v151, s[48:51], s12 offen lds
    s_mov_b32 exec_hi, -1
    s_add_u32 s13, s13, 4096
    s_cmp_lt_u32 s14, 6
    s_cselect_b32 s15, s74, s75
    s_cselect_b32 s8, 4, -6
    s_subb_u32 s76, s76, -1
    s_add_u32 s12, s12, s15
    s_add_u32 s14, s14, s8
    s_cmp_eq_u32 s76, 9
    s_cselect_b32 s8, 1152, 0
    s_cselect_b32 s76, 0, s76
    s_sub_u32 s12, s12, s8
    s_mov_b32 m0, s13
    s_cmp_eq_u32 s14, 9
    s_cselect_b32 exec_hi, 0x00ffffff, -1
    buffer_load_dwordx4 v151, s[48:51], s12 offen lds
    s_mov_b32 exec_hi, -1
    s_add_u32 s13, s13, 4096
    s_cmp_lt_u32 s14, 6
    s_cselect_b32 s15, s74, s75
    s_cselect_b32 s8, 4, -6
    s_subb_u32 s76, s76, -1
    s_add_u32 s12, s12, s15
    s_add_u32 s14, s14, s8
    s_cmp_eq_u32 s76, 9
    s_cselect_b32 s8, 1152, 0
    s_cselect_b32 s76, 0, s76
    s_sub_u32 s12, s12, s8
    s_mov_b32 m0, s13
    s_cmp_eq_u32 s14, 9
    s_cselect_b32 exec_hi, 0x00ffffff, -1
    buffer_load_dwordx4 v151, s[48:51], s12 offen lds
    s_mov_b32 exec_hi, -1
    s_add_u32 s13, s13, 4096
    s_cmp_lt_u32 s14, 6
    s_cselect_b32 s15, s74, s75
    s_cselect_b32 s8, 4, -6
    s_subb_u32 s76, s76, -1
    s_add_u32 s12, s12, s15
    s_add_u32 s14, s14, s8
    s_cmp_eq_u32 s76, 9
    s_cselect_b32 s8, 1152, 0
    s_cselect_b32 s76, 0, s76
    s_sub_u32 s12, s12, s8
    s_mov_b32 m0, s13
    s_cmp_eq_u32 s14, 9
    s_cselect_b32 exec_hi, 0x00ffffff, -1
    buffer_load_dwordx4 v151, s[48:51], s12 offen lds
    s_mov_b32 exec_hi, -1
    s_add_u32 s13, s13, 4096
    s_cmp_lt_u32 s14, 6
    s_cselect_b32 s15, s74, s75
    s_cselect_b32 s8, 4, -6
    s_subb_u32 s76, s76, -1
    s_add_u32 s12, s12, s15
    s_add_u32 s14, s14, s8
    s_cmp_eq_u32 s76, 9
    s_cselect_b32 s8, 1152, 0
    s_cselect_b32 s76, 0, s76
    s_sub_u32 s12, s12, s8
    s_mov_b32 m0, s13
    s_cmp_eq_u32 s14, 9
    s_cselect_b32 exec_hi, 0x00ffffff, -1
    buffer_load_dwordx4 v151, s[48:51], s12 offen lds
    s_mov_b32 exec_hi, -1
    s_add_u32 s13, s13, 4096
    s_cmp_lt_u32 s14, 6
    s_cselect_b32 s15, s74, s75
    s_cselect_b32 s8, 4, -6
    s_subb_u32 s76, s76, -1
    s_add_u32 s12, s12, s15
    s_add_u32 s14, s14, s8
    s_cmp_eq_u32 s76, 9
    s_cselect_b32 s8, 1152, 0
    s_cselect_b32 s76, 0, s76
    s_sub_u32 s12, s12, s8
    s_mov_b32 m0, s13
    s_cmp_eq_u32 s14, 9
    s_cselect_b32 exec_hi, 0x00ffffff, -1
    buffer_load_dwordx4 v151, s[48:51], s12 offen lds
    s_mov_b32 exec_hi, -1
    s_add_u32 s13, s13, 4096
    s_cmp_lt_u32 s14, 6
    s_cselect_b32 s15, s74, s75
    s_cselect_b32 s8, 4, -6
    s_subb_u32 s76, s76, -1
    s_add_u32 s12, s12, s15
    s_add_u32 s14, s14, s8
    s_cmp_eq_u32 s76, 9
    s_cselect_b32 s8, 1152, 0
    s_cselect_b32 s76, 0, s76
    s_sub_u32 s12, s12, s8
    s_waitcnt lgkmcnt(0)
    s_barrier
    s_mov_b32 m0, s13
    s_cmp_eq_u32 s14, 9
    s_cselect_b32 exec_hi, 0x00ffffff, -1
    buffer_load_dwordx4 v151, s[48:51], s12 offen lds
    s_mov_b32 exec_hi, -1
    s_add_u32 s13, s13, 4096
    s_cmp_lt_u32 s14, 6
    s_cselect_b32 s15, s74, s75
    s_cselect_b32 s8, 4, -6
    s_subb_u32 s76, s76, -1
    s_add_u32 s12, s12, s15
    s_add_u32 s14, s14, s8
    s_cmp_eq_u32 s76, 9
    s_cselect_b32 s8, 1152, 0
    s_cselect_b32 s76, 0, s76
    s_sub_u32 s12, s12, s8
    s_mov_b32 m0, s13
    s_cmp_eq_u32 s14, 9
    s_cselect_b32 exec_hi, 0x00ffffff, -1
    buffer_load_dwordx4 v151, s[48:51], s12 offen lds
    s_mov_b32 exec_hi, -1
    s_add_u32 s13, s13, 4096
    s_cmp_lt_u32 s14, 6
    s_cselect_b32 s15, s74, s75
    s_cselect_b32 s8, 4, -6
    s_subb_u32 s76, s76, -1
    s_add_u32 s12, s12, s15
    s_add_u32 s14, s14, s8
    s_cmp_eq_u32 s76, 9
    s_cselect_b32 s8, 1152, 0
    s_cselect_b32 s76, 0, s76
    s_sub_u32 s12, s12, s8
    s_and_b32 s8, s4, 1
    s_lshl_b32 s8, s8, 6
    v_xor_b32 v8, s8, v10
    s_lshr_b32 s8, s4, 1
    s_mul_i32 s8, s8, 10240
    v_add_u32 v8, s8, v8
    v_add_u32 v9, 40960, v8
    s_lshl_b32 s10, s4, 2
    s_add_u32 s10, s10, 153600
    v_lshl_add_u32 v5, v0, 4, s10
    s_barrier
    s_mov_b32 m0, s13
    s_cmp_eq_u32 s14, 9
    s_cselect_b32 exec_hi, 0x00ffffff, -1
    buffer_load_dwordx4 v151, s[48:51], s12 offen lds
    s_mov_b32 exec_hi, -1
    s_add_u32 s13, s13, 4096
    s_cmp_lt_u32 s14, 6
    s_cselect_b32 s15, s74, s75
    s_cselect_b32 s8, 4, -6
    s_subb_u32 s76, s76, -1
    s_add_u32 s12, s12, s15
    s_add_u32 s14, s14, s8
    s_cmp_eq_u32 s76, 9
    s_cselect_b32 s8, 1152, 0
    s_cselect_b32 s76, 0, s76
    s_sub_u32 s12, s12, s8
    s_mov_b32 m0, s13
    s_cmp_eq_u32 s14, 9
    s_cselect_b32 exec_hi, 0x00ffffff, -1
    buffer_load_dwordx4 v151, s[48:51], s12 offen lds
    s_mov_b32 exec_hi, -1
    s_add_u32 s13, s13, 4096
    s_cmp_lt_u32 s14, 6
    s_cselect_b32 s15, s74, s75
    s_cselect_b32 s8, 4, -6
    s_subb_u32 s76, s76, -1
    s_add_u32 s12, s12, s15
    s_add_u32 s14, s14, s8
    s_cmp_eq_u32 s76, 9
    s_cselect_b32 s8, 1152, 0
    s_cselect_b32 s76, 0, s76
    s_sub_u32 s12, s12, s8
    s_waitcnt vmcnt(11)
    s_barrier
    s_mov_b32 m0, s13
    s_cmp_eq_u32 s14, 9
    s_cselect_b32 exec_hi, 0x00ffffff, -1
    buffer_load_dwordx4 v151, s[48:51], s12 offen lds
    s_mov_b32 exec_hi, -1
    s_add_u32 s13, s13, 4096
    s_cmp_lt_u32 s14, 6
    s_cselect_b32 s15, s74, s75
    s_cselect_b32 s8, 4, -6
    s_subb_u32 s76, s76, -1
    s_add_u32 s12, s12, s15
    s_add_u32 s14, s14, s8
    s_cmp_eq_u32 s76, 9
    s_cselect_b32 s8, 1152, 0
    s_cselect_b32 s76, 0, s76
    s_sub_u32 s12, s12, s8
    s_barrier
    s_mov_b32 m0, s13
    s_cmp_eq_u32 s14, 9
    s_cselect_b32 exec_hi, 0x00ffffff, -1
    buffer_load_dwordx4 v151, s[48:51], s12 offen lds
    s_mov_b32 exec_hi, -1
    s_add_u32 s13, s13, 4096
    s_cmp_lt_u32 s14, 6
    s_cselect_b32 s15, s74, s75
    s_cselect_b32 s8, 4, -6
    s_subb_u32 s76, s76, -1
    s_add_u32 s12, s12, s15
    s_add_u32 s14, s14, s8
    s_cmp_eq_u32 s76, 9
    s_cselect_b32 s8, 1152, 0
    s_cselect_b32 s76, 0, s76
    s_sub_u32 s12, s12, s8
    ds_read_b128 v[96:99], v8 offset:0
    ds_read_b128 v[100:103], v8 offset:2048
    ds_read_b128 v[104:107], v8 offset:4096
    ds_read_b128 v[108:111], v8 offset:6144
    ds_read_b128 v[112:115], v8 offset:8192
    s_waitcnt vmcnt(10)
    s_barrier
    s_mov_b32 m0, s13
    s_cmp_eq_u32 s14, 9
    s_cselect_b32 exec_hi, 0x00ffffff, -1
    buffer_load_dwordx4 v151, s[48:51], s12 offen lds
    s_mov_b32 exec_hi, -1
    s_add_u32 s13, s13, 4096
    s_cmp_lt_u32 s14, 6
    s_cselect_b32 s15, s74, s75
    s_cselect_b32 s8, 4, -6
    s_subb_u32 s76, s76, -1
    s_add_u32 s12, s12, s15
    s_add_u32 s14, s14, s8
    s_cmp_eq_u32 s76, 9
    s_cselect_b32 s8, 1152, 0
    s_cselect_b32 s76, 0, s76
    s_sub_u32 s12, s12, s8
    s_waitcnt lgkmcnt(0)
    v_mfma_f32_16x16x32_bf16 v[12:15], v[72:75], v[96:99], 0
    v_mfma_f32_16x16x32_bf16 v[16:19], v[72:75], v[100:103], 0
    v_mfma_f32_16x16x32_bf16 v[20:23], v[72:75], v[104:107], 0
    v_mfma_f32_16x16x32_bf16 v[24:27], v[72:75], v[108:111], 0
    v_mfma_f32_16x16x32_bf16 v[28:31], v[72:75], v[112:115], 0
    s_barrier
    s_mov_b32 m0, s13
    s_cmp_eq_u32 s14, 9
    s_cselect_b32 exec_hi, 0x00ffffff, -1
    buffer_load_dwordx4 v151, s[48:51], s12 offen lds
    s_mov_b32 exec_hi, -1
    s_add_u32 s13, s13, 4096
    s_cmp_lt_u32 s14, 6
    s_cselect_b32 s15, s74, s75
    s_cselect_b32 s8, 4, -6
    s_subb_u32 s76, s76, -1
    s_add_u32 s12, s12, s15
    s_add_u32 s14, s14, s8
    s_cmp_eq_u32 s76, 9
    s_cselect_b32 s8, 1152, 0
    s_cselect_b32 s76, 0, s76
    s_sub_u32 s12, s12, s8
    s_mov_b32 s9, 0x40000000
    s_mul_i32 s10, s46, 786432
    s_mul_i32 s11, s4, 65536
    s_add_u32 s10, s10, s11
    s_xor_b32 s11, s47, 0
    s_cselect_b32 s32, 0, s9
    s_mul_i32 s11, s11, 1024
    s_add_u32 s32, s32, s11
    s_add_u32 s32, s32, s10
    s_xor_b32 s11, s47, 1
    s_cselect_b32 s33, 8192, s9
    s_mul_i32 s11, s11, 1024
    s_add_u32 s33, s33, s11
    s_add_u32 s33, s33, s10
    s_xor_b32 s11, s47, 2
    s_cselect_b32 s34, 16384, s9
    s_mul_i32 s11, s11, 1024
    s_add_u32 s34, s34, s11
    s_add_u32 s34, s34, s10
    s_xor_b32 s11, s47, 3
    s_cselect_b32 s35, 24576, s9
    s_mul_i32 s11, s11, 1024
    s_add_u32 s35, s35, s11
    s_add_u32 s35, s35, s10
    s_waitcnt vmcnt(10)
    s_barrier
    s_mov_b32 m0, s13
    s_cmp_eq_u32 s14, 9
    s_cselect_b32 exec_hi, 0x00ffffff, -1
    buffer_load_dwordx4 v151, s[48:51], s12 offen lds
    s_mov_b32 exec_hi, -1
    s_add_u32 s13, s13, 4096
    s_cmp_lt_u32 s14, 6
    s_cselect_b32 s15, s74, s75
    s_cselect_b32 s8, 4, -6
    s_subb_u32 s76, s76, -1
    s_add_u32 s12, s12, s15
    s_add_u32 s14, s14, s8
    s_cmp_eq_u32 s76, 9
    s_cselect_b32 s8, 1152, 0
    s_cselect_b32 s76, 0, s76
    s_sub_u32 s12, s12, s8
    s_xor_b32 s11, s47, 4
    s_cselect_b32 s36, 32768, s9
    s_mul_i32 s11, s11, 1024
    s_add_u32 s36, s36, s11
    s_add_u32 s36, s36, s10
    s_xor_b32 s11, s47, 5
    s_cselect_b32 s37, 40960, s9
    s_mul_i32 s11, s11, 1024
    s_add_u32 s37, s37, s11
    s_add_u32 s37, s37, s10
    s_xor_b32 s11, s47, 6
    s_cselect_b32 s38, 49152, s9
    s_mul_i32 s11, s11, 1024
    s_add_u32 s38, s38, s11
    s_add_u32 s38, s38, s10
    s_xor_b32 s11, s47, 7
    s_cselect_b32 s39, 57344, s9
    s_mul_i32 s11, s11, 1024
    s_add_u32 s39, s39, s11
    s_add_u32 s39, s39, s10
    s_barrier
    s_mov_b32 m0, s13
    s_cmp_eq_u32 s14, 9
    s_cselect_b32 exec_hi, 0x00ffffff, -1
    buffer_load_dwordx4 v151, s[48:51], s12 offen lds
    s_mov_b32 exec_hi, -1
    s_add_u32 s13, s13, 4096
    s_cmp_lt_u32 s14, 6
    s_cselect_b32 s15, s74, s75
    s_cselect_b32 s8, 4, -6
    s_subb_u32 s76, s76, -1
    s_add_u32 s12, s12, s15
    s_add_u32 s14, s14, s8
    s_cmp_eq_u32 s76, 9
    s_cselect_b32 s8, 1152, 0
    s_cselect_b32 s76, 0, s76
    s_sub_u32 s12, s12, s8
    ds_read_b128 v[116:119], v8 offset:20480
    ds_read_b128 v[120:123], v8 offset:22528
    ds_read_b128 v[124:127], v8 offset:24576
    ds_read_b128 v[128:131], v8 offset:26624
    ds_read_b128 v[132:135], v8 offset:28672
    s_waitcnt vmcnt(9)
    s_barrier
    s_cmp_ge_u32 s4, 2
    s_cbranch_scc1 L_x23
    s_mov_b32 m0, s13
    s_cmp_eq_u32 s14, 9
    s_cselect_b32 exec_hi, 0x00ffffff, -1
    buffer_load_dwordx4 v151, s[48:51], s12 offen lds
    s_mov_b32 exec_hi, -1
L_x23:
    s_waitcnt lgkmcnt(0)
    v_mfma_f32_16x16x32_bf16 v[12:15], v[72:75], v[116:119], v[12:15]
    v_mfma_f32_16x16x32_bf16 v[16:19], v[72:75], v[120:123], v[16:19]
    v_mfma_f32_16x16x32_bf16 v[20:23], v[72:75], v[124:127], v[20:23]
    v_mfma_f32_16x16x32_bf16 v[24:27], v[72:75], v[128:131], v[24:27]
    v_mfma_f32_16x16x32_bf16 v[28:31], v[72:75], v[132:135], v[28:31]
    s_barrier
    v_lshrrev_b32 v6, 4, v0
    v_and_b32 v7, 15, v0
    v_lshlrev_b32 v150, 7, v7
    v_and_b32 v7, 7, v7
    v_and_b32 v149, 1, v6
    v_lshrrev_b32 v6, 1, v6
    v_xor_b32 v6, v6, v7
    s_lshl_b32 s9, s4, 1
    v_xor_b32 v7, s9, v6
    v_lshl_add_u32 v7, v7, 4, v150
    v_add_u32 v7, 61440, v7
    v_lshl_add_u32 v147, v149, 3, v7
    v_lshl_add_u32 v148, v149, 11, v7
    s_waitcnt vmcnt(7)
    s_barrier
    s_barrier
    ds_read_b128 v[96:99], v9 offset:0
    ds_read_b128 v[100:103], v9 offset:2048
    ds_read_b128 v[104:107], v9 offset:4096
    ds_read_b128 v[108:111], v9 offset:6144
    ds_read_b128 v[112:115], v9 offset:8192
    s_waitcnt vmcnt(5)
    s_barrier
    s_waitcnt lgkmcnt(0)
    v_mfma_f32_16x16x32_bf16 v[12:15], v[72:75], v[96:99], v[12:15]
    v_mfma_f32_16x16x32_bf16 v[16:19], v[72:75], v[100:103], v[16:19]
    v_mfma_f32_16x16x32_bf16 v[20:23], v[72:75], v[104:107], v[20:23]
    v_mfma_f32_16x16x32_bf16 v[24:27], v[72:75], v[108:111], v[24:27]
    v_mfma_f32_16x16x32_bf16 v[28:31], v[72:75], v[112:115], v[28:31]
    s_waitcnt vmcnt(2)
    s_barrier
    ds_read_b128 v[116:119], v9 offset:20480
    ds_read_b128 v[120:123], v9 offset:22528
    ds_read_b128 v[124:127], v9 offset:24576
    ds_read_b128 v[128:131], v9 offset:26624
    ds_read_b128 v[132:135], v9 offset:28672
    s_waitcnt vmcnt(0)
    s_barrier
    s_waitcnt lgkmcnt(0)
    v_mfma_f32_16x16x32_bf16 v[12:15], v[72:75], v[116:119], v[12:15]
    v_mfma_f32_16x16x32_bf16 v[16:19], v[72:75], v[120:123], v[16:19]
    v_mfma_f32_16x16x32_bf16 v[20:23], v[72:75], v[124:127], v[20:23]
    v_mfma_f32_16x16x32_bf16 v[24:27], v[72:75], v[128:131], v[24:27]
    v_mfma_f32_16x16x32_bf16 v[28:31], v[72:75], v[132:135], v[28:31]
    s_cmp_ge_u32 s4, 2
    s_cbranch_scc1 L_st4
    ds_read_b128 v[96:99], v9 offset:40960
    ds_read_b128 v[100:103], v9 offset:43008
    ds_read_b128 v[104:107], v9 offset:45056
    ds_read_b128 v[108:111], v9 offset:47104
    ds_read_b128 v[112:115], v9 offset:49152
L_st4:
    s_barrier
    s_cmp_ge_u32 s4, 2
    s_cbranch_scc1 L_st5
    s_waitcnt lgkmcnt(0)
    v_mfma_f32_16x16x32_bf16 v[12:15], v[72:75], v[96:99], v[12:15]
    v_mfma_f32_16x16x32_bf16 v[16:19], v[72:75], v[100:103], v[16:19]
    v_mfma_f32_16x16x32_bf16 v[20:23], v[72:75], v[104:107], v[20:23]
    v_mfma_f32_16x16x32_bf16 v[24:27], v[72:75], v[108:111], v[24:27]
    v_mfma_f32_16x16x32_bf16 v[28:31], v[72:75], v[112:115], v[28:31]
L_st5:
    s_barrier
    s_nop 7
    s_mov_b64 exec, 0xffff
    s_lshl_b64 exec, exec, 16
    v_mov_b32 v12, v16
    s_lshl_b64 exec, exec, 16
    v_mov_b32 v12, v20
    s_lshl_b64 exec, exec, 16
    v_mov_b32 v12, v24
    s_mov_b64 exec, -1
    ds_write_b32 v5, v12
    s_mov_b64 exec, 0xffff
    ds_write_b32 v5, v28 offset:1024
    s_mov_b64 exec, -1
    s_barrier
    s_barrier
    v_subrev_u32 v4, 40960, v10
    v_xor_b32 v5, 64, v4
    ds_read_b64_tr_b16 v[72:73], v1 offset:36864
    ds_read_b64_tr_b16 v[74:75], v1 offset:37376
    ds_read_b64_tr_b16 v[76:77], v2 offset:36864
    ds_read_b64_tr_b16 v[78:79], v2 offset:37376
    ds_read_b64_tr_b16 v[80:81], v3 offset:36864
    ds_read_b64_tr_b16 v[82:83], v3 offset:37376
    ds_read_b128 v[96:99], v4 offset:40960
    ds_read_b128 v[100:103], v4 offset:43008
    ds_read_b128 v[104:107], v4 offset:45056
    ds_read_b128 v[108:111], v4 offset:47104
    s_mov_b32 s71, 8
    s_mov_b32 s69, 1
    s_setprio 2
.p2align 3
    s_waitcnt lgkmcnt(0)
    s_barrier
    v_mfma_f32_16x16x32_bf16 v[12:15], v[72:75], v[96:99], 0
    v_mfma_f32_16x16x32_bf16 v[16:19], v[76:79], v[96:99], 0
    v_mfma_f32_16x16x32_bf16 v[20:23], v[80:83], v[96:99], 0
    v_mfma_f32_16x16x32_bf16 v[32:35], v[80:83], v[100:103], 0
    ds_read_b128 v[112:115], v4 offset:49152
    v_mfma_f32_16x16x32_bf16 v[28:31], v[76:79], v[100:103], 0
    ds_read_b64_tr_b16 v[84:85], v1 offset:49152
    ds_read_b64_tr_b16 v[86:87], v1 offset:49664
    v_mfma_f32_16x16x32_bf16 v[24:27], v[72:75], v[100:103], 0
    ds_read_b128 v[96:99], v5 offset:40960
    s_waitcnt lgkmcnt(5)
    s_nop 0
    v_mfma_f32_16x16x32_bf16 v[36:39], v[72:75], v[104:107], 0
    ds_read_b64_tr_b16 v[88:89], v2 offset:49152
    ds_read_b64_tr_b16 v[90:91], v2 offset:49664
    v_mfma_f32_16x16x32_bf16 v[40:43], v[76:79], v[104:107], 0
    ds_read_b128 v[100:103], v5 offset:43008
    v_mfma_f32_16x16x32_bf16 v[44:47], v[80:83], v[104:107], 0
    s_waitcnt lgkmcnt(7)
    s_nop 0
    ds_read_b64_tr_b16 v[92:93], v3 offset:49152
    v_mfma_f32_16x16x32_bf16 v[56:59], v[80:83], v[108:111], 0
    ds_read_b64_tr_b16 v[94:95], v3 offset:49664
    ds_read_b128 v[104:107], v5 offset:45056
    v_mfma_f32_16x16x32_bf16 v[52:55], v[76:79], v[108:111], 0
    v_mfma_f32_16x16x32_bf16 v[48:51], v[72:75], v[108:111], 0
    s_waitcnt lgkmcnt(9)
    s_nop 0
    v_mfma_f32_16x16x32_bf16 v[60:63], v[72:75], v[112:115], 0
    ds_read_b128 v[108:111], v5 offset:47104
    v_mfma_f32_16x16x32_bf16 v[64:67], v[76:79], v[112:115], 0
    v_mfma_f32_16x16x32_bf16 v[68:71], v[80:83], v[112:115], 0
    s_waitcnt lgkmcnt(2)
    s_barrier
    s_branch L_a9
L_ret1:
    v_lshrrev_b32 v6, 5, v0
    v_and_b32 v7, 7, v0
    v_xor_b32 v6, v6, v7
    v_lshlrev_b32 v6, 4, v6
    v_and_b32 v7, 15, v0
    v_lshl_add_u32 v6, v7, 7, v6
    v_bfe_u32 v7, v0, 4, 1
    v_lshl_add_u32 v6, v7, 3, v6
    s_sub_u32 s8, s47, 5
    s_lshl_b32 s8, s8, 1
    s_add_u32 s9, s4, 24
    s_cmp_lt_u32 s47, 5
    s_cselect_b32 s8, s47, s8
    s_cselect_b32 s10, s4, 8
    s_cselect_b32 s11, 1, 0
    s_add_u32 s9, s9, s10
    s_lshr_b32 s10, s9, 2
    s_sub_u32 s10, s10, s101
    s_barrier
    s_cselect_b32 s100, 9, 0
    s_add_u32 s10, s10, s100
    s_mul_i32 s10, s10, 5
    s_add_u32 s10, s10, s8
    s_lshl_b32 s10, s10, 11
    s_and_b32 s100, s9, 3
    s_lshl_b32 s100, s100, 5
    s_or_b32 s10, s10, s100
    v_xor_b32 v152, s10, v6
    s_add_u32 s9, s9, s11
    s_xor_b32 s11, s11, 1
    s_add_u32 s8, s8, s11
    s_lshr_b32 s10, s9, 2
    s_sub_u32 s10, s10, s101
    s_cselect_b32 s100, 9, 0
    s_add_u32 s10, s10, s100
    s_mul_i32 s10, s10, 5
    s_add_u32 s10, s10, s8
    s_barrier
    s_lshl_b32 s10, s10, 11
    s_and_b32 s100, s9, 3
    s_lshl_b32 s100, s100, 5
    s_or_b32 s10, s10, s100
    v_xor_b32 v162, s10, v6
    ds_read_b64 v[152:153], v152 offset:61440
    ds_read_b64 v[162:163], v162 offset:61440
    v_and_b32 v6, 15, v0
    v_lshlrev_b32 v6, 4, v6
    v_add_u32 v6, 153600, v6
    ds_read_b128 v[72:75], v6 offset:0
    ds_read_b128 v[76:79], v6 offset:256
    ds_read_b128 v[80:83], v6 offset:512
    ds_read_b128 v[84:87], v6 offset:768
    ds_read_b128 v[88:91], v6 offset:1024
    s_barrier
    s_waitcnt lgkmcnt(0)
    v_add_f32 v72, v72, v73
    v_add_f32 v74, v74, v75
    v_add_f32 v72, v72, v74
    v_mul_f32 v72, 0xbae38e39, v72
    v_cvt_pk_bf16_f32 v72, v72, v72
    v_lshlrev_b32 v154, 16, v72
    v_add_f32 v76, v76, v77
    v_add_f32 v78, v78, v79
    v_add_f32 v76, v76, v78
    v_mul_f32 v76, 0xbae38e39, v76
    v_cvt_pk_bf16_f32 v76, v76, v76
    v_lshlrev_b32 v155, 16, v76
    v_add_f32 v80, v80, v81
    v_add_f32 v82, v82, v83
    v_add_f32 v80, v80, v82
    v_mul_f32 v80, 0xbae38e39, v80
    v_cvt_pk_bf16_f32 v80, v80, v80
    s_barrier
    v_lshlrev_b32 v156, 16, v80
    v_add_f32 v84, v84, v85
    v_add_f32 v86, v86, v87
    v_add_f32 v84, v84, v86
    v_mul_f32 v84, 0xbae38e39, v84
    v_cvt_pk_bf16_f32 v84, v84, v84
    v_lshlrev_b32 v157, 16, v84
    v_add_f32 v88, v88, v89
    v_add_f32 v90, v90, v91
    v_add_f32 v88, v88, v90
    v_mul_f32 v88, 0xbae38e39, v88
    v_cvt_pk_bf16_f32 v88, v88, v88
    v_lshlrev_b32 v158, 16, v88
    v_fmac_f32_dpp v12, v60, v154 row_newbcast:15 row_mask:0xf bank_mask:0xf
    v_fmac_f32_dpp v13, v61, v154 row_newbcast:15 row_mask:0xf bank_mask:0xf
    v_fmac_f32_dpp v14, v62, v154 row_newbcast:15 row_mask:0xf bank_mask:0xf
    v_fmac_f32_dpp v15, v63, v154 row_newbcast:15 row_mask:0xf bank_mask:0xf
    v_cvt_pk_bf16_f32 v116, v12, v13
    s_barrier
    v_cvt_pk_bf16_f32 v117, v14, v15
    v_pk_max_i16 v116, v116, 0
    v_pk_max_i16 v117, v117, 0
    v_fmac_f32_dpp v24, v60, v155 row_newbcast:15 row_mask:0xf bank_mask:0xf
    v_fmac_f32_dpp v25, v61, v155 row_newbcast:15 row_mask:0xf bank_mask:0xf
    v_fmac_f32_dpp v26, v62, v155 row_newbcast:15 row_mask:0xf bank_mask:0xf
    v_fmac_f32_dpp v27, v63, v155 row_newbcast:15 row_mask:0xf bank_mask:0xf
    v_cvt_pk_bf16_f32 v118, v24, v25
    v_cvt_pk_bf16_f32 v119, v26, v27
    v_pk_max_i16 v118, v118, 0
    v_pk_max_i16 v119, v119, 0
    v_fmac_f32_dpp v36, v60, v156 row_newbcast:15 row_mask:0xf bank_mask:0xf
    v_fmac_f32_dpp v37, v61, v156 row_newbcast:15 row_mask:0xf bank_mask:0xf
    v_fmac_f32_dpp v38, v62, v156 row_newbcast:15 row_mask:0xf bank_mask:0xf
    v_fmac_f32_dpp v39, v63, v156 row_newbcast:15 row_mask:0xf bank_mask:0xf
    v_permlane16_swap_b32 v116, v118
    v_permlane16_swap_b32 v117, v119
    v_cvt_pk_bf16_f32 v120, v36, v37
    s_barrier
    s_setprio 3
    ds_write_b128 v148, v[116:119] offset:0
    s_setprio 0
    v_cvt_pk_bf16_f32 v121, v38, v39
    v_pk_max_i16 v120, v120, 0
    v_pk_max_i16 v121, v121, 0
    v_fmac_f32_dpp v48, v60, v157 row_newbcast:15 row_mask:0xf bank_mask:0xf
    v_fmac_f32_dpp v49, v61, v157 row_newbcast:15 row_mask:0xf bank_mask:0xf
    v_fmac_f32_dpp v50, v62, v157 row_newbcast:15 row_mask:0xf bank_mask:0xf
    v_fmac_f32_dpp v51, v63, v157 row_newbcast:15 row_mask:0xf bank_mask:0xf
    v_cvt_pk_bf16_f32 v122, v48, v49
    v_cvt_pk_bf16_f32 v123, v50, v51
    v_pk_max_i16 v122, v122, 0
    v_pk_max_i16 v123, v123, 0
    v_fmac_f32_dpp v60, v60, v158 row_newbcast:15 row_mask:0xf bank_mask:0xf
    v_fmac_f32_dpp v61, v61, v158 row_newbcast:15 row_mask:0xf bank_mask:0xf
    v_fmac_f32_dpp v62, v62, v158 row_newbcast:15 row_mask:0xf bank_mask:0xf
    v_fmac_f32_dpp v63, v63, v158 row_newbcast:15 row_mask:0xf bank_mask:0xf
    v_permlane16_swap_b32 v120, v122
    v_permlane16_swap_b32 v121, v123
    v_cvt_pk_bf16_f32 v124, v60, v61
    s_barrier
    s_setprio 3
    ds_write_b128 v148, v[120:123] offset:4096
    s_setprio 0
    v_cvt_pk_bf16_f32 v125, v62, v63
    v_pk_max_i16 v124, v124, 0
    v_pk_max_i16 v125, v125, 0
    v_fmac_f32_dpp v16, v64, v154 row_newbcast:15 row_mask:0xf bank_mask:0xf
    v_fmac_f32_dpp v17, v65, v154 row_newbcast:15 row_mask:0xf bank_mask:0xf
    v_fmac_f32_dpp v18, v66, v154 row_newbcast:15 row_mask:0xf bank_mask:0xf
    v_fmac_f32_dpp v19, v67, v154 row_newbcast:15 row_mask:0xf bank_mask:0xf
    v_cvt_pk_bf16_f32 v126, v16, v17
    v_cvt_pk_bf16_f32 v127, v18, v19
    v_pk_max_i16 v126, v126, 0
    v_pk_max_i16 v127, v127, 0
    v_fmac_f32_dpp v28, v64, v155 row_newbcast:15 row_mask:0xf bank_mask:0xf
    v_fmac_f32_dpp v29, v65, v155 row_newbcast:15 row_mask:0xf bank_mask:0xf
    v_fmac_f32_dpp v30, v66, v155 row_newbcast:15 row_mask:0xf bank_mask:0xf
    v_fmac_f32_dpp v31, v67, v155 row_newbcast:15 row_mask:0xf bank_mask:0xf
    v_cvt_pk_bf16_f32 v128, v28, v29
    v_cvt_pk_bf16_f32 v129, v30, v31
    v_pk_max_i16 v128, v128, 0
    s_barrier
    s_setprio 3
    ds_write_b64 v147, v[124:125] offset:8192
    s_setprio 0
    v_pk_max_i16 v129, v129, 0
    v_fmac_f32_dpp v40, v64, v156 row_newbcast:15 row_mask:0xf bank_mask:0xf
    v_fmac_f32_dpp v41, v65, v156 row_newbcast:15 row_mask:0xf bank_mask:0xf
    v_fmac_f32_dpp v42, v66, v156 row_newbcast:15 row_mask:0xf bank_mask:0xf
    v_fmac_f32_dpp v43, v67, v156 row_newbcast:15 row_mask:0xf bank_mask:0xf
    v_permlane16_swap_b32 v126, v128
    v_permlane16_swap_b32 v127, v129
    v_cvt_pk_bf16_f32 v130, v40, v41
    v_cvt_pk_bf16_f32 v131, v42, v43
    v_pk_max_i16 v130, v130, 0
    v_pk_max_i16 v131, v131, 0
    v_fmac_f32_dpp v52, v64, v157 row_newbcast:15 row_mask:0xf bank_mask:0xf
    v_fmac_f32_dpp v53, v65, v157 row_newbcast:15 row_mask:0xf bank_mask:0xf
    v_fmac_f32_dpp v54, v66, v157 row_newbcast:15 row_mask:0xf bank_mask:0xf
    v_fmac_f32_dpp v55, v67, v157 row_newbcast:15 row_mask:0xf bank_mask:0xf
    v_cvt_pk_bf16_f32 v132, v52, v53
    v_cvt_pk_bf16_f32 v133, v54, v55
    v_pk_max_i16 v132, v132, 0
    s_barrier
    s_setprio 3
    ds_write_b128 v148, v[126:129] offset:10240
    s_setprio 0
    v_pk_max_i16 v133, v133, 0
    v_fmac_f32_dpp v64, v64, v158 row_newbcast:15 row_mask:0xf bank_mask:0xf
    v_fmac_f32_dpp v65, v65, v158 row_newbcast:15 row_mask:0xf bank_mask:0xf
    v_fmac_f32_dpp v66, v66, v158 row_newbcast:15 row_mask:0xf bank_mask:0xf
    v_fmac_f32_dpp v67, v67, v158 row_newbcast:15 row_mask:0xf bank_mask:0xf
    v_permlane16_swap_b32 v130, v132
    v_permlane16_swap_b32 v131, v133
    v_cvt_pk_bf16_f32 v134, v64, v65
    v_cvt_pk_bf16_f32 v135, v66, v67
    v_pk_max_i16 v134, v134, 0
    v_pk_max_i16 v135, v135, 0
    v_fmac_f32_dpp v20, v68, v154 row_newbcast:15 row_mask:0xf bank_mask:0xf
    v_fmac_f32_dpp v21, v69, v154 row_newbcast:15 row_mask:0xf bank_mask:0xf
    v_fmac_f32_dpp v22, v70, v154 row_newbcast:15 row_mask:0xf bank_mask:0xf
    v_fmac_f32_dpp v23, v71, v154 row_newbcast:15 row_mask:0xf bank_mask:0xf
    v_cvt_pk_bf16_f32 v136, v20, v21
    v_cvt_pk_bf16_f32 v137, v22, v23
    v_pk_max_i16 v136, v136, 0
    s_barrier
    s_setprio 3
    ds_write_b128 v148, v[130:133] offset:14336
    s_setprio 0
    v_pk_max_i16 v137, v137, 0
    v_fmac_f32_dpp v32, v68, v155 row_newbcast:15 row_mask:0xf bank_mask:0xf
    v_fmac_f32_dpp v33, v69, v155 row_newbcast:15 row_mask:0xf bank_mask:0xf
    v_fmac_f32_dpp v34, v70, v155 row_newbcast:15 row_mask:0xf bank_mask:0xf
    v_fmac_f32_dpp v35, v71, v155 row_newbcast:15 row_mask:0xf bank_mask:0xf
    v_cvt_pk_bf16_f32 v138, v32, v33
    v_cvt_pk_bf16_f32 v139, v34, v35
    v_pk_max_i16 v138, v138, 0
    v_pk_max_i16 v139, v139, 0
    v_fmac_f32_dpp v44, v68, v156 row_newbcast:15 row_mask:0xf bank_mask:0xf
    v_fmac_f32_dpp v45, v69, v156 row_newbcast:15 row_mask:0xf bank_mask:0xf
    v_fmac_f32_dpp v46, v70, v156 row_newbcast:15 row_mask:0xf bank_mask:0xf
    v_fmac_f32_dpp v47, v71, v156 row_newbcast:15 row_mask:0xf bank_mask:0xf
    v_permlane16_swap_b32 v136, v138
    v_permlane16_swap_b32 v137, v139
    v_cvt_pk_bf16_f32 v140, v44, v45
    v_cvt_pk_bf16_f32 v141, v46, v47
    v_pk_max_i16 v140, v140, 0
    s_barrier
    s_setprio 3
    ds_write_b64 v147, v[134:135] offset:18432
    s_setprio 0
    v_pk_max_i16 v141, v141, 0
    v_fmac_f32_dpp v56, v68, v157 row_newbcast:15 row_mask:0xf bank_mask:0xf
    v_fmac_f32_dpp v57, v69, v157 row_newbcast:15 row_mask:0xf bank_mask:0xf
    v_fmac_f32_dpp v58, v70, v157 row_newbcast:15 row_mask:0xf bank_mask:0xf
    v_fmac_f32_dpp v59, v71, v157 row_newbcast:15 row_mask:0xf bank_mask:0xf
    v_cvt_pk_bf16_f32 v142, v56, v57
    v_cvt_pk_bf16_f32 v143, v58, v59
    v_pk_max_i16 v142, v142, 0
    v_pk_max_i16 v143, v143, 0
    v_fmac_f32_dpp v68, v68, v158 row_newbcast:15 row_mask:0xf bank_mask:0xf
    v_fmac_f32_dpp v69, v69, v158 row_newbcast:15 row_mask:0xf bank_mask:0xf
    v_fmac_f32_dpp v70, v70, v158 row_newbcast:15 row_mask:0xf bank_mask:0xf
    v_fmac_f32_dpp v71, v71, v158 row_newbcast:15 row_mask:0xf bank_mask:0xf
    v_permlane16_swap_b32 v140, v142
    v_permlane16_swap_b32 v141, v143
    v_cvt_pk_bf16_f32 v144, v68, v69
    v_cvt_pk_bf16_f32 v145, v70, v71
    v_pk_max_i16 v144, v144, 0
    s_barrier
    s_setprio 3
    ds_write_b128 v148, v[136:139] offset:20480
    s_setprio 0
    v_pk_max_i16 v145, v145, 0
    v_lshrrev_b32 v6, 4, v0
    v_bfe_u32 v7, v0, 2, 2
    v_mul_u32_u24 v8, 24, v6
    v_add_lshl_u32 v8, v8, v7, 7
    v_and_b32 v9, 3, v0
    v_lshl_add_u32 v8, v9, 3, v8
    v_lshrrev_b32 v7, 1, v7
    v_and_b32 v9, 1, v6
    v_lshl_or_b32 v7, v9, 1, v7
    s_mul_i32 s8, s4, 2
    s_add_u32 s8, s8, 0
    s_and_b32 s9, s8, 3
    s_lshr_b32 s8, s8, 2
    s_lshl_b32 s8, s8, 10
    v_xor_b32 v9, s9, v7
    v_lshl_add_u32 v1, v9, 5, v8
    v_add_u32 v1, s8, v1
    s_barrier
    s_setprio 3
    ds_write_b128 v148, v[140:143] offset:24576
    s_setprio 0
    s_mul_i32 s8, s4, 2
    s_add_u32 s8, s8, 1
    s_and_b32 s9, s8, 3
    s_lshr_b32 s8, s8, 2
    s_lshl_b32 s8, s8, 10
    v_xor_b32 v9, s9, v7
    v_lshl_add_u32 v2, v9, 5, v8
    v_add_u32 v2, s8, v2
    s_mul_i32 s8, s4, 1
    s_add_u32 s8, s8, 8
    s_and_b32 s9, s8, 3
    s_lshr_b32 s8, s8, 2
    s_lshl_b32 s8, s8, 10
    v_xor_b32 v9, s9, v7
    v_lshl_add_u32 v3, v9, 5, v8
    v_add_u32 v3, s8, v3
    s_load_dword s79, s[42:43], 0
    s_mul_i32 s8, s46, 1536
    s_barrier
    s_setprio 3
    ds_write_b64 v147, v[144:145] offset:28672
    s_setprio 0
    s_mul_i32 s9, s4, 128
    s_add_u32 s8, s8, s9
    s_lshl_b32 s9, s47, 2
    s_add_u32 s8, s8, s9
    s_add_u32 s72, s8, 29360128
    s_barrier
    s_barrier
    s_waitcnt lgkmcnt(0)
    s_barrier
    s_cmp_ge_u32 s79, 43
    s_cbranch_scc1 L_zok
    v_mov_b32 v6, 0
L_zpoll:
    s_mov_b64 exec, 1
    global_load_dword v7, v6, s[42:43] sc0 sc1
    s_waitcnt vmcnt(0)
    v_cmp_gt_u32 vcc, 43, v7
    s_mov_b64 exec, -1
    s_cbranch_vccnz L_zpoll
L_zok:
    v_subrev_u32 v4, 20480, v10
    v_xor_b32 v5, 64, v4
    ds_read_b64_tr_b16 v[72:73], v1 offset:49152
    ds_read_b64_tr_b16 v[74:75], v1 offset:49664
    ds_read_b64_tr_b16 v[76:77], v2 offset:49152
    ds_read_b64_tr_b16 v[78:79], v2 offset:49664
    ds_read_b64_tr_b16 v[80:81], v3 offset:49152
    ds_read_b64_tr_b16 v[82:83], v3 offset:49664
    ds_read_b128 v[96:99], v4 offset:20480
    ds_read_b128 v[100:103], v4 offset:22528
    ds_read_b128 v[104:107], v4 offset:24576
    ds_read_b128 v[108:111], v4 offset:26624
    s_mov_b32 s71, 8
    s_mov_b32 s69, 3
    s_setprio 2
.p2align 3
    s_waitcnt lgkmcnt(0)
    s_barrier
    v_mfma_f32_16x16x32_bf16 v[12:15], v[72:75], v[96:99], 0
    v_mfma_f32_16x16x32_bf16 v[16:19], v[76:79], v[96:99], 0
    v_mfma_f32_16x16x32_bf16 v[20:23], v[80:83], v[96:99], 0
    v_mfma_f32_16x16x32_bf16 v[32:35], v[80:83], v[100:103], 0
    ds_read_b128 v[112:115], v4 offset:28672
    v_mfma_f32_16x16x32_bf16 v[28:31], v[76:79], v[100:103], 0
    ds_read_b64_tr_b16 v[84:85], v1 offset:0
    ds_read_b64_tr_b16 v[86:87], v1 offset:512
    v_mfma_f32_16x16x32_bf16 v[24:27], v[72:75], v[100:103], 0
    ds_read_b128 v[96:99], v5 offset:20480
    s_waitcnt lgkmcnt(5)
    s_nop 0
    v_mfma_f32_16x16x32_bf16 v[36:39], v[72:75], v[104:107], 0
    ds_read_b64_tr_b16 v[88:89], v2 offset:0
    ds_read_b64_tr_b16 v[90:91], v2 offset:512
    v_mfma_f32_16x16x32_bf16 v[40:43], v[76:79], v[104:107], 0
    ds_read_b128 v[100:103], v5 offset:22528
    v_mfma_f32_16x16x32_bf16 v[44:47], v[80:83], v[104:107], 0
    s_waitcnt lgkmcnt(7)
    s_nop 0
    ds_read_b64_tr_b16 v[92:93], v3 offset:0
    v_mfma_f32_16x16x32_bf16 v[56:59], v[80:83], v[108:111], 0
    ds_read_b64_tr_b16 v[94:95], v3 offset:512
    ds_read_b128 v[104:107], v5 offset:24576
    v_mfma_f32_16x16x32_bf16 v[52:55], v[76:79], v[108:111], 0
    v_mfma_f32_16x16x32_bf16 v[48:51], v[72:75], v[108:111], 0
    s_waitcnt lgkmcnt(9)
    s_nop 0
    v_mfma_f32_16x16x32_bf16 v[60:63], v[72:75], v[112:115], 0
    ds_read_b128 v[108:111], v5 offset:26624
    v_mfma_f32_16x16x32_bf16 v[64:67], v[76:79], v[112:115], 0
    v_mfma_f32_16x16x32_bf16 v[68:71], v[80:83], v[112:115], 0
    s_waitcnt lgkmcnt(2)
    s_barrier
    s_branch L_a5
L_ret3:
    v_lshlrev_b32 v150, 4, v0
    s_lshl_b32 s8, s4, 10
    s_add_u32 s8, s8, 153600
    v_add_u32 v159, s8, v150
    v_cvt_pk_bf16_f32 v116, v12, v13
    v_cvt_pk_bf16_f32 v117, v14, v15
    v_cvt_pk_bf16_f32 v118, v16, v17
    v_cvt_pk_bf16_f32 v119, v18, v19
    v_cvt_pk_bf16_f32 v136, v20, v21
    v_cvt_pk_bf16_f32 v137, v22, v23
    s_barrier
    buffer_store_dwordx4 v[116:119], v150, s[60:63], s32 offen sc0 sc1
    v_cvt_pk_bf16_f32 v120, v24, v25
    v_cvt_pk_bf16_f32 v121, v26, v27
    v_cvt_pk_bf16_f32 v122, v28, v29
    v_cvt_pk_bf16_f32 v123, v30, v31
    v_cvt_pk_bf16_f32 v138, v32, v33
    v_cvt_pk_bf16_f32 v139, v34, v35
    s_barrier
    buffer_store_dwordx4 v[120:123], v150, s[60:63], s33 offen sc0 sc1
    s_barrier
    s_barrier
    buffer_store_dwordx4 v[136:139], v150, s[60:63], s37 offen sc0 sc1
    v_cvt_pk_bf16_f32 v124, v36, v37
    v_cvt_pk_bf16_f32 v125, v38, v39
    v_cvt_pk_bf16_f32 v126, v40, v41
    v_cvt_pk_bf16_f32 v127, v42, v43
    v_cvt_pk_bf16_f32 v140, v44, v45
    v_cvt_pk_bf16_f32 v141, v46, v47
    s_barrier
    buffer_store_dwordx4 v[124:127], v150, s[60:63], s34 offen sc0 sc1
    s_barrier
    v_cvt_pk_bf16_f32 v128, v48, v49
    v_cvt_pk_bf16_f32 v129, v50, v51
    v_cvt_pk_bf16_f32 v130, v52, v53
    v_cvt_pk_bf16_f32 v131, v54, v55
    v_cvt_pk_bf16_f32 v142, v56, v57
    v_cvt_pk_bf16_f32 v143, v58, v59
    s_barrier
    buffer_store_dwordx4 v[128:131], v150, s[60:63], s35 offen sc0 sc1
    s_barrier
    s_barrier
    buffer_store_dwordx4 v[140:143], v150, s[60:63], s38 offen sc0 sc1
    v_cvt_pk_bf16_f32 v132, v60, v61
    v_cvt_pk_bf16_f32 v133, v62, v63
    v_cvt_pk_bf16_f32 v134, v64, v65
    v_cvt_pk_bf16_f32 v135, v66, v67
    v_cvt_pk_bf16_f32 v144, v68, v69
    v_cvt_pk_bf16_f32 v145, v70, v71
    s_lshl_b32 s8, s47, 2
    s_set_gpr_idx_on s8, gpr_idx(SRC0)
    v_mov_b32 v164, v116
    v_mov_b32 v165, v117
    v_mov_b32 v166, v118
    v_mov_b32 v167, v119
    s_set_gpr_idx_off
    v_permlane32_swap_b32 v144, v146
    v_permlane32_swap_b32 v145, v147
    s_barrier
    buffer_store_dwordx4 v[132:135], v150, s[60:63], s36 offen sc0 sc1
    s_barrier
    s_barrier
    s_mov_b32 exec_hi, 0
    buffer_store_dwordx4 v[144:147], v150, s[60:63], s39 offen sc0 sc1
    s_mov_b32 exec_hi, -1
    s_barrier
    s_setprio 3
    ds_write_b128 v159, v[164:167]
    s_setprio 0
    s_barrier
    s_barrier
    s_barrier
    v_mov_b32 v6, 4
    s_add_u32 s8, s72, 0
    s_mov_b64 exec, 1
    s_waitcnt vmcnt(0) lgkmcnt(0)
    buffer_store_dword v6, off, s[60:63], s8 sc0 sc1
    s_mov_b64 exec, -1
    s_barrier
    v_subrev_u32 v4, 0, v10
    v_xor_b32 v5, 64, v4
    ds_read_b64_tr_b16 v[72:73], v1 offset:0
    ds_read_b64_tr_b16 v[74:75], v1 offset:512
    ds_read_b64_tr_b16 v[76:77], v2 offset:0
    ds_read_b64_tr_b16 v[78:79], v2 offset:512
    ds_read_b64_tr_b16 v[80:81], v3 offset:0
    ds_read_b64_tr_b16 v[82:83], v3 offset:512
    ds_read_b128 v[96:99], v4 offset:0
    ds_read_b128 v[100:103], v4 offset:2048
    ds_read_b128 v[104:107], v4 offset:4096
    ds_read_b128 v[108:111], v4 offset:6144
    s_mov_b32 s71, 7
    s_mov_b32 s69, 5
    s_setprio 2
.p2align 3
    s_waitcnt lgkmcnt(0)
    s_barrier
    v_mfma_f32_16x16x32_bf16 v[12:15], v[72:75], v[96:99], 0
    v_mfma_f32_16x16x32_bf16 v[16:19], v[76:79], v[96:99], 0
    v_mfma_f32_16x16x32_bf16 v[20:23], v[80:83], v[96:99], 0
    v_mfma_f32_16x16x32_bf16 v[32:35], v[80:83], v[100:103], 0
    ds_read_b128 v[112:115], v4 offset:8192
    v_mfma_f32_16x16x32_bf16 v[28:31], v[76:79], v[100:103], 0
    ds_read_b64_tr_b16 v[84:85], v1 offset:12288
    ds_read_b64_tr_b16 v[86:87], v1 offset:12800
    v_mfma_f32_16x16x32_bf16 v[24:27], v[72:75], v[100:103], 0
    ds_read_b128 v[96:99], v5 offset:0
    s_waitcnt lgkmcnt(5)
    s_nop 0
    v_mfma_f32_16x16x32_bf16 v[36:39], v[72:75], v[104:107], 0
    ds_read_b64_tr_b16 v[88:89], v2 offset:12288
    ds_read_b64_tr_b16 v[90:91], v2 offset:12800
    v_mfma_f32_16x16x32_bf16 v[40:43], v[76:79], v[104:107], 0
    ds_read_b128 v[100:103], v5 offset:2048
    v_mfma_f32_16x16x32_bf16 v[44:47], v[80:83], v[104:107], 0
    s_waitcnt lgkmcnt(7)
    s_nop 0
    ds_read_b64_tr_b16 v[92:93], v3 offset:12288
    v_mfma_f32_16x16x32_bf16 v[56:59], v[80:83], v[108:111], 0
    ds_read_b64_tr_b16 v[94:95], v3 offset:12800
    ds_read_b128 v[104:107], v5 offset:4096
    v_mfma_f32_16x16x32_bf16 v[52:55], v[76:79], v[108:111], 0
    v_mfma_f32_16x16x32_bf16 v[48:51], v[72:75], v[108:111], 0
    s_waitcnt lgkmcnt(9)
    s_nop 0
    v_mfma_f32_16x16x32_bf16 v[60:63], v[72:75], v[112:115], 0
    ds_read_b128 v[108:111], v5 offset:6144
    v_mfma_f32_16x16x32_bf16 v[64:67], v[76:79], v[112:115], 0
    v_mfma_f32_16x16x32_bf16 v[68:71], v[80:83], v[112:115], 0
    s_waitcnt lgkmcnt(2)
    s_barrier
    s_branch L_a1
.p2align 3
L_ret5:
    v_mfma_f32_16x16x32_bf16 v[12:15], v[84:87], v[96:99], v[12:15]
    v_mfma_f32_16x16x32_bf16 v[16:19], v[88:91], v[96:99], v[16:19]
    v_mfma_f32_16x16x32_bf16 v[20:23], v[92:95], v[96:99], v[20:23]
    v_mfma_f32_16x16x32_bf16 v[32:35], v[92:95], v[100:103], v[32:35]
    ds_read_b128 v[112:115], v5 offset:28672
    v_mfma_f32_16x16x32_bf16 v[28:31], v[88:91], v[100:103], v[28:31]
    ds_read_b64_tr_b16 v[72:73], v1 offset:12288
    ds_read_b64_tr_b16 v[74:75], v1 offset:12800
    v_mfma_f32_16x16x32_bf16 v[24:27], v[84:87], v[100:103], v[24:27]
    ds_read_b128 v[96:99], v4 offset:30720
    s_waitcnt lgkmcnt(5)
    s_nop 0
    v_mfma_f32_16x16x32_bf16 v[36:39], v[84:87], v[104:107], v[36:39]
    ds_read_b64_tr_b16 v[76:77], v2 offset:12288
    ds_read_b64_tr_b16 v[78:79], v2 offset:12800
    v_mfma_f32_16x16x32_bf16 v[40:43], v[88:91], v[104:107], v[40:43]
    ds_read_b128 v[100:103], v4 offset:32768
    v_mfma_f32_16x16x32_bf16 v[44:47], v[92:95], v[104:107], v[44:47]
    s_waitcnt lgkmcnt(7)
    s_nop 0
    ds_read_b64_tr_b16 v[80:81], v3 offset:12288
    v_mfma_f32_16x16x32_bf16 v[56:59], v[92:95], v[108:111], v[56:59]
    ds_read_b64_tr_b16 v[82:83], v3 offset:12800
    ds_read_b128 v[104:107], v4 offset:34816
    v_mfma_f32_16x16x32_bf16 v[52:55], v[88:91], v[108:111], v[52:55]
    v_mfma_f32_16x16x32_bf16 v[48:51], v[84:87], v[108:111], v[48:51]
    s_waitcnt lgkmcnt(9)
    s_nop 0
    v_mfma_f32_16x16x32_bf16 v[60:63], v[84:87], v[112:115], v[60:63]
    ds_read_b128 v[108:111], v4 offset:36864
    v_mfma_f32_16x16x32_bf16 v[64:67], v[88:91], v[112:115], v[64:67]
    v_mfma_f32_16x16x32_bf16 v[68:71], v[92:95], v[112:115], v[68:71]
    s_waitcnt lgkmcnt(2)
    s_barrier
    v_mfma_f32_16x16x32_bf16 v[12:15], v[72:75], v[96:99], v[12:15]
    v_mfma_f32_16x16x32_bf16 v[16:19], v[76:79], v[96:99], v[16:19]
    v_mfma_f32_16x16x32_bf16 v[20:23], v[80:83], v[96:99], v[20:23]
    v_mfma_f32_16x16x32_bf16 v[32:35], v[80:83], v[100:103], v[32:35]
    ds_read_b128 v[112:115], v4 offset:38912
    v_mfma_f32_16x16x32_bf16 v[28:31], v[76:79], v[100:103], v[28:31]
    ds_read_b64_tr_b16 v[84:85], v1 offset:24576
    ds_read_b64_tr_b16 v[86:87], v1 offset:25088
    v_mfma_f32_16x16x32_bf16 v[24:27], v[72:75], v[100:103], v[24:27]
    ds_read_b128 v[96:99], v5 offset:30720
    s_waitcnt lgkmcnt(5)
    s_nop 0
    v_mfma_f32_16x16x32_bf16 v[36:39], v[72:75], v[104:107], v[36:39]
    ds_read_b64_tr_b16 v[88:89], v2 offset:24576
    ds_read_b64_tr_b16 v[90:91], v2 offset:25088
    v_mfma_f32_16x16x32_bf16 v[40:43], v[76:79], v[104:107], v[40:43]
    ds_read_b128 v[100:103], v5 offset:32768
    v_mfma_f32_16x16x32_bf16 v[44:47], v[80:83], v[104:107], v[44:47]
    s_waitcnt lgkmcnt(7)
    s_nop 0
    ds_read_b64_tr_b16 v[92:93], v3 offset:24576
    v_mfma_f32_16x16x32_bf16 v[56:59], v[80:83], v[108:111], v[56:59]
    ds_read_b64_tr_b16 v[94:95], v3 offset:25088
    ds_read_b128 v[104:107], v5 offset:34816
    v_mfma_f32_16x16x32_bf16 v[52:55], v[76:79], v[108:111], v[52:55]
    v_mfma_f32_16x16x32_bf16 v[48:51], v[72:75], v[108:111], v[48:51]
    s_waitcnt lgkmcnt(9)
    s_nop 0
    v_mfma_f32_16x16x32_bf16 v[60:63], v[72:75], v[112:115], v[60:63]
    ds_read_b128 v[108:111], v5 offset:36864
    v_mfma_f32_16x16x32_bf16 v[64:67], v[76:79], v[112:115], v[64:67]
    v_mfma_f32_16x16x32_bf16 v[68:71], v[80:83], v[112:115], v[68:71]
    s_waitcnt lgkmcnt(2)
    s_nop 0
    v_mfma_f32_16x16x32_bf16 v[12:15], v[84:87], v[96:99], v[12:15]
    ds_read_b128 v[112:115], v11
    v_mfma_f32_16x16x32_bf16 v[16:19], v[88:91], v[96:99], v[16:19]
    v_mfma_f32_16x16x32_bf16 v[20:23], v[92:95], v[96:99], v[20:23]
    v_mfma_f32_16x16x32_bf16 v[32:35], v[92:95], v[100:103], v[32:35]
    v_mfma_f32_16x16x32_bf16 v[28:31], v[88:91], v[100:103], v[28:31]
    v_mfma_f32_16x16x32_bf16 v[24:27], v[84:87], v[100:103], v[24:27]
    s_waitcnt lgkmcnt(2)
    s_nop 0
    v_mfma_f32_16x16x32_bf16 v[36:39], v[84:87], v[104:107], v[36:39]
    v_mfma_f32_16x16x32_bf16 v[40:43], v[88:91], v[104:107], v[40:43]
    v_mfma_f32_16x16x32_bf16 v[44:47], v[92:95], v[104:107], v[44:47]
    s_waitcnt lgkmcnt(0)
    s_nop 0
    v_mfma_f32_16x16x32_bf16 v[56:59], v[92:95], v[108:111], v[56:59]
    v_mfma_f32_16x16x32_bf16 v[52:55], v[88:91], v[108:111], v[52:55]
    v_mfma_f32_16x16x32_bf16 v[48:51], v[84:87], v[108:111], v[48:51]
    v_mfma_f32_16x16x32_bf16 v[60:63], v[84:87], v[112:115], v[60:63]
    v_mfma_f32_16x16x32_bf16 v[64:67], v[88:91], v[112:115], v[64:67]
    v_mfma_f32_16x16x32_bf16 v[68:71], v[92:95], v[112:115], v[68:71]
    s_nop 4
    v_lshlrev_b32 v150, 4, v0
    s_lshl_b32 s8, s4, 10
    s_add_u32 s8, s8, 49152
    v_add_u32 v159, s8, v150
    v_add_u32 v150, 524288, v150
    v_cvt_pk_bf16_f32 v116, v12, v13
    v_cvt_pk_bf16_f32 v117, v14, v15
    v_cvt_pk_bf16_f32 v118, v16, v17
    v_cvt_pk_bf16_f32 v119, v18, v19
    v_cvt_pk_bf16_f32 v136, v20, v21
    v_cvt_pk_bf16_f32 v137, v22, v23
    buffer_store_dwordx4 v[116:119], v150, s[60:63], s32 offen sc0 sc1
    v_cvt_pk_bf16_f32 v120, v24, v25
    v_cvt_pk_bf16_f32 v121, v26, v27
    v_cvt_pk_bf16_f32 v122, v28, v29
    v_cvt_pk_bf16_f32 v123, v30, v31
    v_cvt_pk_bf16_f32 v138, v32, v33
    v_cvt_pk_bf16_f32 v139, v34, v35
    buffer_store_dwordx4 v[120:123], v150, s[60:63], s33 offen sc0 sc1
    buffer_store_dwordx4 v[136:139], v150, s[60:63], s37 offen sc0 sc1
    v_cvt_pk_bf16_f32 v124, v36, v37
    v_cvt_pk_bf16_f32 v125, v38, v39
    v_cvt_pk_bf16_f32 v126, v40, v41
    v_cvt_pk_bf16_f32 v127, v42, v43
    v_cvt_pk_bf16_f32 v140, v44, v45
    v_cvt_pk_bf16_f32 v141, v46, v47
    buffer_store_dwordx4 v[124:127], v150, s[60:63], s34 offen sc0 sc1
    v_cvt_pk_bf16_f32 v128, v48, v49
    v_cvt_pk_bf16_f32 v129, v50, v51
    v_cvt_pk_bf16_f32 v130, v52, v53
    v_cvt_pk_bf16_f32 v131, v54, v55
    v_cvt_pk_bf16_f32 v142, v56, v57
    v_cvt_pk_bf16_f32 v143, v58, v59
    buffer_store_dwordx4 v[128:131], v150, s[60:63], s35 offen sc0 sc1
    buffer_store_dwordx4 v[140:143], v150, s[60:63], s38 offen sc0 sc1
    v_cvt_pk_bf16_f32 v132, v60, v61
    v_cvt_pk_bf16_f32 v133, v62, v63
    v_cvt_pk_bf16_f32 v134, v64, v65
    v_cvt_pk_bf16_f32 v135, v66, v67
    v_cvt_pk_bf16_f32 v144, v68, v69
    v_cvt_pk_bf16_f32 v145, v70, v71
    buffer_store_dwordx4 v[132:135], v150, s[60:63], s36 offen sc0 sc1
    s_lshl_b32 s8, s47, 2
    s_set_gpr_idx_on s8, gpr_idx(SRC0)
    v_mov_b32 v164, v116
    v_mov_b32 v165, v117
    v_mov_b32 v166, v118
    v_mov_b32 v167, v119
    s_set_gpr_idx_off
    ds_write_b128 v159, v[164:167]
    v_permlane32_swap_b32 v144, v146
    v_permlane32_swap_b32 v145, v147
    s_mov_b32 exec_hi, 0
    buffer_store_dwordx4 v[144:147], v150, s[60:63], s39 offen sc0 sc1
    s_mov_b32 exec_hi, -1
    s_lshl_b32 s79, s3, 10
    s_add_u32 s79, s79, 36864
    s_mul_i32 s74, s46, 12
    s_mov_b32 s78, 4
    s_add_u32 s74, s74, s4
    s_add_u32 s74, s74, 8
    s_mov_b32 s75, s47
    s_mov_b32 s25, 49152
    s_mov_b32 s77, 0
    s_mul_i32 s7, s74, 128
    s_add_u32 s7, s7, 29360128
    v_cmp_gt_u32 vcc, 8, v0
    v_mov_b32 v161, s78
    v_xor_b32 v7, s47, v0
    v_cndmask_b32 v7, v0, v7, vcc
    v_lshlrev_b32 v7, 2, v7
    v_cndmask_b32 v161, 1, v161, vcc
    s_lshl_b32 s8, s4, 10
    s_add_u32 s8, s8, s25
    v_lshl_add_u32 v76, v0, 4, s8
    s_mul_i32 s27, s74, 0x1556
    s_lshr_b32 s27, s27, 16
    s_mul_i32 s28, s27, 12
    s_sub_u32 s28, s74, s28
    s_mul_i32 s27, s27, 79
    s_and_b32 s29, s28, 3
    s_lshr_b32 s28, s28, 2
    s_mul_i32 s28, s28, 12
    s_add_u32 s28, s28, s29
    s_lshl_b32 s28, s28, 2
    s_lshl_b32 s29, s29, 2
    s_mul_i32 s10, s74, 65536
    v_and_b32 v2, 15, v0
    v_lshrrev_b32 v3, 4, v0
    s_bfe_u32 s6, s75, 196608
    s_mul_i32 s12, s6, 8192
    s_cmp_eq_u32 s6, 7
    s_cselect_b32 s11, 504, 0
    v_lshrrev_b32 v4, 5, v0
    v_mul_u32_u24 v4, s11, v4
    v_lshlrev_b32 v74, 4, v0
    v_sub_u32 v74, v74, v4
    s_cselect_b32 s11, 496, -1
    v_min_u32 v74, s11, v74
    v_add_u32 v74, s12, v74
    s_sub_u32 s12, s6, 5
    s_lshl_b32 s12, s12, 1
    s_cmp_lt_u32 s6, 5
    s_cselect_b32 s13, s6, s12
    s_cselect_b32 s14, 0, 128
    s_cselect_b32 s15, s29, 32
    s_cselect_b32 s18, 65536, 0
    s_cselect_b32 s19, 2, 1
    s_cselect_b32 s20, 3, 1
    s_cselect_b32 s26, 32, 512
    s_lshl_b32 s13, s13, 4
    s_add_u32 s9, s28, s15
    v_lshrrev_b32 v4, s19, v0
    v_add_u32 v4, s13, v4
    v_and_b32 v5, s20, v0
    v_add_u32 v6, s27, v4
    v_mul_u32_u24 v44, 1152, v6
    s_lshl_b32 s12, s9, 3
    v_lshl_add_u32 v5, v5, 4, s12
    v_add_u32 v44, v44, v5
    v_cmp_lt_u32 vcc, 78, v4
    v_mov_b32 v6, 0x8000000
    s_add_u32 s12, s79, 0
    v_lshl_add_u32 v45, v0, 4, s12
    v_cndmask_b32 v44, v44, v6, vcc
    s_add_u32 s19, s19, 4
    v_lshlrev_b32 v4, s19, v2
    v_lshl_add_u32 v4, v3, 3, v4
    v_add_u32 v72, s12, v4
    v_add_u32 v73, s26, v72
    s_add_u32 s8, s27, s13
    v_add_lshl_u32 v60, v2, s8, 3
    v_add_u32 v61, s14, v60
    v_min_u32 v60, 16376, v60
    v_min_u32 v61, 16376, v61
    v_add_lshl_u32 v5, v3, s9, 14
    v_add_u32 v62, v5, v60
    v_add3_u32 v63, v5, v61, s18
    s_mov_b32 s21, 20971520
    s_mov_b32 s22, 25165824
    s_mov_b32 s23, 0
    s_mov_b64 exec, 0xfffff
    buffer_load_dword v160, v7, s[60:63], s7 offen sc0 sc1
    s_mov_b64 exec, -1
    v_mov_b32 v6, 4
    s_add_u32 s8, s72, 1024
    s_mov_b64 exec, 1
    s_waitcnt vmcnt(1) lgkmcnt(0)
    buffer_store_dword v6, off, s[60:63], s8 sc0 sc1
    s_mov_b64 exec, -1
    s_waitcnt vmcnt(1)
    s_branch L_red1_mid2
    v_mov_b32 v6, 4
    s_add_u32 s8, s72, 1024
    s_mov_b64 exec, 1
    s_waitcnt vmcnt(0) lgkmcnt(0)
    buffer_store_dword v6, off, s[60:63], s8 sc0 sc1
    s_mov_b64 exec, -1
    s_endpgm
L_gE:
    s_barrier
    s_cmp_lg_u32 s3, 7
    s_cbranch_scc1 L_nopf_1
    s_getpc_b64 s[6:7]
L_pc_2:
    s_sub_u32 s6, s6, L_pc_2-parallel_sum__ssm_conv_s4__dense_activation_relu__prompt_kernel
    s_subb_u32 s7, s7, 0
    s_lshr_b32 s10, s2, 3
    s_mul_i32 s11, s10, 52
    s_lshr_b32 s11, s11, 8
    s_mul_i32 s11, s11, 5
    s_sub_u32 s10, s10, s11
    s_lshl_b32 s10, s10, 13
    v_lshlrev_b32 v1, 7, v0
    v_add_u32 v1, s10, v1
    v_min_u32 v1, L_code_end-parallel_sum__ssm_conv_s4__dense_activation_relu__prompt_kernel, v1
    global_load_dword v167, v1, s[6:7]
L_nopf_1:
    s_mov_b32 s64, 0x3f803f80
    s_mov_b32 s65, 0x00003f80
    s_mov_b32 s66, 0x3f800000
    s_waitcnt lgkmcnt(0)
    s_mov_b32 s48, s16
    s_and_b32 s49, s17, 0xffff
    s_mov_b32 s50, 2359296
    s_mov_b32 s51, 0x20000
    s_mov_b32 s60, s44
    s_and_b32 s61, s45, 0xffff
    s_mov_b32 s62, 268435456
    s_mov_b32 s63, 0x20000
    v_lshrrev_b32 v6, 4, v0
    v_bfe_u32 v7, v0, 2, 2
    v_mul_u32_u24 v8, 24, v6
    v_add_lshl_u32 v8, v8, v7, 7
    v_and_b32 v9, 3, v0
    v_lshl_add_u32 v8, v9, 3, v8
    v_lshrrev_b32 v7, 1, v7
    v_and_b32 v9, 1, v6
    v_lshl_or_b32 v7, v9, 1, v7
    v_xor_b32 v9, s4, v7
    v_lshl_add_u32 v1, v9, 5, v8
    v_add_u32 v2, 1024, v1
    v_add_u32 v3, 2048, v1
    v_and_b32 v5, 15, v0
    v_and_b32 v7, 7, v5
    v_xor_b32 v7, v6, v7
    v_lshlrev_b32 v7, 4, v7
    v_lshl_add_u32 v7, v5, 7, v7
    v_add_u32 v10, 61440, v7
    v_xor_b32 v11, 64, v10
    v_add_u32 v11, 90112, v11
    s_mov_b32 s9, 0x40000000
    s_mul_i32 s10, s46, 786432
    s_mul_i32 s11, s4, 65536
    s_add_u32 s10, s10, s11
    s_xor_b32 s11, s47, 0
    s_cselect_b32 s32, 0, s9
    s_mul_i32 s11, s11, 1024
    s_add_u32 s32, s32, s11
    s_add_u32 s32, s32, s10
    s_xor_b32 s11, s47, 1
    s_cselect_b32 s33, 8192, s9
    s_mul_i32 s11, s11, 1024
    s_add_u32 s33, s33, s11
    s_add_u32 s33, s33, s10
    s_xor_b32 s11, s47, 2
    s_cselect_b32 s34, 16384, s9
    s_mul_i32 s11, s11, 1024
    s_add_u32 s34, s34, s11
    s_add_u32 s34, s34, s10
    s_xor_b32 s11, s47, 3
    s_cselect_b32 s35, 24576, s9
    s_mul_i32 s11, s11, 1024
    s_add_u32 s35, s35, s11
    s_add_u32 s35, s35, s10
    s_xor_b32 s11, s47, 4
    s_cselect_b32 s36, 32768, s9
    s_mul_i32 s11, s11, 1024
    s_add_u32 s36, s36, s11
    s_add_u32 s36, s36, s10
    s_xor_b32 s11, s47, 5
    s_cselect_b32 s37, 40960, s9
    s_mul_i32 s11, s11, 1024
    s_add_u32 s37, s37, s11
    s_add_u32 s37, s37, s10
    s_xor_b32 s11, s47, 6
    s_cselect_b32 s38, 49152, s9
    s_mul_i32 s11, s11, 1024
    s_add_u32 s38, s38, s11
    s_add_u32 s38, s38, s10
    s_xor_b32 s11, s47, 7
    s_cselect_b32 s39, 57344, s9
    s_mul_i32 s11, s11, 1024
    s_add_u32 s39, s39, s11
    s_add_u32 s39, s39, s10
    v_lshrrev_b32 v6, 4, v0
    v_and_b32 v7, 15, v0
    v_lshlrev_b32 v150, 7, v7
    v_and_b32 v7, 7, v7
    v_and_b32 v149, 1, v6
    v_lshrrev_b32 v6, 1, v6
    v_xor_b32 v6, v6, v7
    s_lshl_b32 s9, s4, 1
    v_xor_b32 v7, s9, v6
    v_lshl_add_u32 v7, v7, 4, v150
    v_add_u32 v7, 92160, v7
    v_lshl_add_u32 v147, v149, 3, v7
    v_lshl_add_u32 v148, v149, 11, v7
    s_barrier
    v_subrev_u32 v4, 0, v10
    v_xor_b32 v5, 64, v4
    ds_read_b64_tr_b16 v[72:73], v1 offset:0
    ds_read_b64_tr_b16 v[74:75], v1 offset:512
    ds_read_b64_tr_b16 v[76:77], v2 offset:0
    ds_read_b64_tr_b16 v[78:79], v2 offset:512
    ds_read_b64_tr_b16 v[80:81], v3 offset:0
    ds_read_b64_tr_b16 v[82:83], v3 offset:512
    ds_read_b128 v[96:99], v4 offset:0
    ds_read_b128 v[100:103], v4 offset:2048
    ds_read_b128 v[104:107], v4 offset:4096
    ds_read_b128 v[108:111], v4 offset:6144
    s_mov_b32 s71, 8
    s_mov_b32 s69, 0
    s_setprio 2
.p2align 3
    s_waitcnt lgkmcnt(0)
    s_barrier
    v_mfma_f32_16x16x32_bf16 v[12:15], v[72:75], v[96:99], 0
    v_mfma_f32_16x16x32_bf16 v[16:19], v[76:79], v[96:99], 0
    v_mfma_f32_16x16x32_bf16 v[20:23], v[80:83], v[96:99], 0
    v_mfma_f32_16x16x32_bf16 v[32:35], v[80:83], v[100:103], 0
    ds_read_b128 v[112:115], v4 offset:8192
    v_mfma_f32_16x16x32_bf16 v[28:31], v[76:79], v[100:103], 0
    ds_read_b64_tr_b16 v[84:85], v1 offset:12288
    ds_read_b64_tr_b16 v[86:87], v1 offset:12800
    v_mfma_f32_16x16x32_bf16 v[24:27], v[72:75], v[100:103], 0
    ds_read_b128 v[96:99], v5 offset:0
    s_waitcnt lgkmcnt(5)
    s_nop 0
    v_mfma_f32_16x16x32_bf16 v[36:39], v[72:75], v[104:107], 0
    ds_read_b64_tr_b16 v[88:89], v2 offset:12288
    ds_read_b64_tr_b16 v[90:91], v2 offset:12800
    v_mfma_f32_16x16x32_bf16 v[40:43], v[76:79], v[104:107], 0
    ds_read_b128 v[100:103], v5 offset:2048
    v_mfma_f32_16x16x32_bf16 v[44:47], v[80:83], v[104:107], 0
    s_waitcnt lgkmcnt(7)
    s_nop 0
    ds_read_b64_tr_b16 v[92:93], v3 offset:12288
    v_mfma_f32_16x16x32_bf16 v[56:59], v[80:83], v[108:111], 0
    ds_read_b64_tr_b16 v[94:95], v3 offset:12800
    ds_read_b128 v[104:107], v5 offset:4096
    v_mfma_f32_16x16x32_bf16 v[52:55], v[76:79], v[108:111], 0
    v_mfma_f32_16x16x32_bf16 v[48:51], v[72:75], v[108:111], 0
    s_waitcnt lgkmcnt(9)
    s_nop 0
    v_mfma_f32_16x16x32_bf16 v[60:63], v[72:75], v[112:115], 0
    ds_read_b128 v[108:111], v5 offset:6144
    v_mfma_f32_16x16x32_bf16 v[64:67], v[76:79], v[112:115], 0
    v_mfma_f32_16x16x32_bf16 v[68:71], v[80:83], v[112:115], 0
    s_waitcnt lgkmcnt(2)
    s_barrier
    s_branch L_a1
L_ret0:
    v_and_b32 v6, 15, v0
    v_lshlrev_b32 v6, 4, v6
    v_add_u32 v6, 153600, v6
    ds_read_b128 v[72:75], v6 offset:0
    ds_read_b128 v[76:79], v6 offset:256
    ds_read_b128 v[80:83], v6 offset:512
    ds_read_b128 v[84:87], v6 offset:768
    ds_read_b128 v[88:91], v6 offset:1024
    s_barrier
    s_waitcnt lgkmcnt(0)
    v_add_f32 v72, v72, v73
    v_add_f32 v74, v74, v75
    v_add_f32 v72, v72, v74
    v_mul_f32 v72, 0xbae38e39, v72
    v_cvt_pk_bf16_f32 v72, v72, v72
    v_lshlrev_b32 v154, 16, v72
    v_add_f32 v76, v76, v77
    v_add_f32 v78, v78, v79
    v_add_f32 v76, v76, v78
    v_mul_f32 v76, 0xbae38e39, v76
    v_cvt_pk_bf16_f32 v76, v76, v76
    v_lshlrev_b32 v155, 16, v76
    v_add_f32 v80, v80, v81
    v_add_f32 v82, v82, v83
    s_barrier
    v_add_f32 v80, v80, v82
    v_mul_f32 v80, 0xbae38e39, v80
    v_cvt_pk_bf16_f32 v80, v80, v80
    v_lshlrev_b32 v156, 16, v80
    v_add_f32 v84, v84, v85
    v_add_f32 v86, v86, v87
    v_add_f32 v84, v84, v86
    v_mul_f32 v84, 0xbae38e39, v84
    v_cvt_pk_bf16_f32 v84, v84, v84
    v_lshlrev_b32 v157, 16, v84
    v_add_f32 v88, v88, v89
    v_add_f32 v90, v90, v91
    v_add_f32 v88, v88, v90
    v_mul_f32 v88, 0xbae38e39, v88
    v_cvt_pk_bf16_f32 v88, v88, v88
    s_barrier
    v_lshlrev_b32 v158, 16, v88
    v_fmac_f32_dpp v12, v60, v154 row_newbcast:15 row_mask:0xf bank_mask:0xf
    v_fmac_f32_dpp v13, v61, v154 row_newbcast:15 row_mask:0xf bank_mask:0xf
    v_fmac_f32_dpp v14, v62, v154 row_newbcast:15 row_mask:0xf bank_mask:0xf
    v_fmac_f32_dpp v15, v63, v154 row_newbcast:15 row_mask:0xf bank_mask:0xf
    v_cvt_pk_bf16_f32 v116, v12, v13
    v_cvt_pk_bf16_f32 v117, v14, v15
    v_pk_max_i16 v116, v116, 0
    v_pk_max_i16 v117, v117, 0
    v_fmac_f32_dpp v24, v60, v155 row_newbcast:15 row_mask:0xf bank_mask:0xf
    v_fmac_f32_dpp v25, v61, v155 row_newbcast:15 row_mask:0xf bank_mask:0xf
    v_fmac_f32_dpp v26, v62, v155 row_newbcast:15 row_mask:0xf bank_mask:0xf
    v_fmac_f32_dpp v27, v63, v155 row_newbcast:15 row_mask:0xf bank_mask:0xf
    v_cvt_pk_bf16_f32 v118, v24, v25
    v_cvt_pk_bf16_f32 v119, v26, v27
    s_barrier
    v_pk_max_i16 v118, v118, 0
    v_pk_max_i16 v119, v119, 0
    v_fmac_f32_dpp v36, v60, v156 row_newbcast:15 row_mask:0xf bank_mask:0xf
    v_fmac_f32_dpp v37, v61, v156 row_newbcast:15 row_mask:0xf bank_mask:0xf
    v_fmac_f32_dpp v38, v62, v156 row_newbcast:15 row_mask:0xf bank_mask:0xf
    v_fmac_f32_dpp v39, v63, v156 row_newbcast:15 row_mask:0xf bank_mask:0xf
    v_permlane16_swap_b32 v116, v118
    v_permlane16_swap_b32 v117, v119
    v_cvt_pk_bf16_f32 v120, v36, v37
    v_cvt_pk_bf16_f32 v121, v38, v39
    v_pk_max_i16 v120, v120, 0
    v_pk_max_i16 v121, v121, 0
    v_fmac_f32_dpp v48, v60, v157 row_newbcast:15 row_mask:0xf bank_mask:0xf
    v_fmac_f32_dpp v49, v61, v157 row_newbcast:15 row_mask:0xf bank_mask:0xf
    v_fmac_f32_dpp v50, v62, v157 row_newbcast:15 row_mask:0xf bank_mask:0xf
    s_barrier
    v_fmac_f32_dpp v51, v63, v157 row_newbcast:15 row_mask:0xf bank_mask:0xf
    v_cvt_pk_bf16_f32 v122, v48, v49
    v_cvt_pk_bf16_f32 v123, v50, v51
    v_pk_max_i16 v122, v122, 0
    v_pk_max_i16 v123, v123, 0
    v_fmac_f32_dpp v60, v60, v158 row_newbcast:15 row_mask:0xf bank_mask:0xf
    v_fmac_f32_dpp v61, v61, v158 row_newbcast:15 row_mask:0xf bank_mask:0xf
    v_fmac_f32_dpp v62, v62, v158 row_newbcast:15 row_mask:0xf bank_mask:0xf
    v_fmac_f32_dpp v63, v63, v158 row_newbcast:15 row_mask:0xf bank_mask:0xf
    v_permlane16_swap_b32 v120, v122
    v_permlane16_swap_b32 v121, v123
    v_cvt_pk_bf16_f32 v124, v60, v61
    v_cvt_pk_bf16_f32 v125, v62, v63
    v_pk_max_i16 v124, v124, 0
    v_pk_max_i16 v125, v125, 0
    s_barrier
    v_fmac_f32_dpp v16, v64, v154 row_newbcast:15 row_mask:0xf bank_mask:0xf
    v_fmac_f32_dpp v17, v65, v154 row_newbcast:15 row_mask:0xf bank_mask:0xf
    v_fmac_f32_dpp v18, v66, v154 row_newbcast:15 row_mask:0xf bank_mask:0xf
    v_fmac_f32_dpp v19, v67, v154 row_newbcast:15 row_mask:0xf bank_mask:0xf
    v_cvt_pk_bf16_f32 v126, v16, v17
    v_cvt_pk_bf16_f32 v127, v18, v19
    v_pk_max_i16 v126, v126, 0
    v_pk_max_i16 v127, v127, 0
    v_fmac_f32_dpp v28, v64, v155 row_newbcast:15 row_mask:0xf bank_mask:0xf
    v_fmac_f32_dpp v29, v65, v155 row_newbcast:15 row_mask:0xf bank_mask:0xf
    v_fmac_f32_dpp v30, v66, v155 row_newbcast:15 row_mask:0xf bank_mask:0xf
    v_fmac_f32_dpp v31, v67, v155 row_newbcast:15 row_mask:0xf bank_mask:0xf
    v_cvt_pk_bf16_f32 v128, v28, v29
    v_cvt_pk_bf16_f32 v129, v30, v31
    v_pk_max_i16 v128, v128, 0
    s_barrier
    v_pk_max_i16 v129, v129, 0
    v_fmac_f32_dpp v40, v64, v156 row_newbcast:15 row_mask:0xf bank_mask:0xf
    v_fmac_f32_dpp v41, v65, v156 row_newbcast:15 row_mask:0xf bank_mask:0xf
    v_fmac_f32_dpp v42, v66, v156 row_newbcast:15 row_mask:0xf bank_mask:0xf
    v_fmac_f32_dpp v43, v67, v156 row_newbcast:15 row_mask:0xf bank_mask:0xf
    v_permlane16_swap_b32 v126, v128
    v_permlane16_swap_b32 v127, v129
    v_cvt_pk_bf16_f32 v130, v40, v41
    v_cvt_pk_bf16_f32 v131, v42, v43
    v_pk_max_i16 v130, v130, 0
    v_pk_max_i16 v131, v131, 0
    v_fmac_f32_dpp v52, v64, v157 row_newbcast:15 row_mask:0xf bank_mask:0xf
    v_fmac_f32_dpp v53, v65, v157 row_newbcast:15 row_mask:0xf bank_mask:0xf
    v_fmac_f32_dpp v54, v66, v157 row_newbcast:15 row_mask:0xf bank_mask:0xf
    v_fmac_f32_dpp v55, v67, v157 row_newbcast:15 row_mask:0xf bank_mask:0xf
    s_barrier
    v_cvt_pk_bf16_f32 v132, v52, v53
    v_cvt_pk_bf16_f32 v133, v54, v55
    v_pk_max_i16 v132, v132, 0
    v_pk_max_i16 v133, v133, 0
    v_fmac_f32_dpp v64, v64, v158 row_newbcast:15 row_mask:0xf bank_mask:0xf
    v_fmac_f32_dpp v65, v65, v158 row_newbcast:15 row_mask:0xf bank_mask:0xf
    v_fmac_f32_dpp v66, v66, v158 row_newbcast:15 row_mask:0xf bank_mask:0xf
    v_fmac_f32_dpp v67, v67, v158 row_newbcast:15 row_mask:0xf bank_mask:0xf
    v_permlane16_swap_b32 v130, v132
    v_permlane16_swap_b32 v131, v133
    v_cvt_pk_bf16_f32 v134, v64, v65
    v_cvt_pk_bf16_f32 v135, v66, v67
    v_pk_max_i16 v134, v134, 0
    v_pk_max_i16 v135, v135, 0
    v_fmac_f32_dpp v20, v68, v154 row_newbcast:15 row_mask:0xf bank_mask:0xf
    s_barrier
    v_fmac_f32_dpp v21, v69, v154 row_newbcast:15 row_mask:0xf bank_mask:0xf
    v_fmac_f32_dpp v22, v70, v154 row_newbcast:15 row_mask:0xf bank_mask:0xf
    v_fmac_f32_dpp v23, v71, v154 row_newbcast:15 row_mask:0xf bank_mask:0xf
    v_cvt_pk_bf16_f32 v136, v20, v21
    v_cvt_pk_bf16_f32 v137, v22, v23
    v_pk_max_i16 v136, v136, 0
    v_pk_max_i16 v137, v137, 0
    v_fmac_f32_dpp v32, v68, v155 row_newbcast:15 row_mask:0xf bank_mask:0xf
    v_fmac_f32_dpp v33, v69, v155 row_newbcast:15 row_mask:0xf bank_mask:0xf
    v_fmac_f32_dpp v34, v70, v155 row_newbcast:15 row_mask:0xf bank_mask:0xf
    v_fmac_f32_dpp v35, v71, v155 row_newbcast:15 row_mask:0xf bank_mask:0xf
    v_cvt_pk_bf16_f32 v138, v32, v33
    v_cvt_pk_bf16_f32 v139, v34, v35
    v_pk_max_i16 v138, v138, 0
    v_pk_max_i16 v139, v139, 0
    s_barrier
    v_fmac_f32_dpp v44, v68, v156 row_newbcast:15 row_mask:0xf bank_mask:0xf
    v_fmac_f32_dpp v45, v69, v156 row_newbcast:15 row_mask:0xf bank_mask:0xf
    v_fmac_f32_dpp v46, v70, v156 row_newbcast:15 row_mask:0xf bank_mask:0xf
    v_fmac_f32_dpp v47, v71, v156 row_newbcast:15 row_mask:0xf bank_mask:0xf
    v_permlane16_swap_b32 v136, v138
    v_permlane16_swap_b32 v137, v139
    v_cvt_pk_bf16_f32 v140, v44, v45
    v_cvt_pk_bf16_f32 v141, v46, v47
    v_pk_max_i16 v140, v140, 0
    v_pk_max_i16 v141, v141, 0
    v_fmac_f32_dpp v56, v68, v157 row_newbcast:15 row_mask:0xf bank_mask:0xf
    v_fmac_f32_dpp v57, v69, v157 row_newbcast:15 row_mask:0xf bank_mask:0xf
    v_fmac_f32_dpp v58, v70, v157 row_newbcast:15 row_mask:0xf bank_mask:0xf
    v_fmac_f32_dpp v59, v71, v157 row_newbcast:15 row_mask:0xf bank_mask:0xf
    v_cvt_pk_bf16_f32 v142, v56, v57
    s_barrier
    v_cvt_pk_bf16_f32 v143, v58, v59
    v_pk_max_i16 v142, v142, 0
    v_pk_max_i16 v143, v143, 0
    v_fmac_f32_dpp v68, v68, v158 row_newbcast:15 row_mask:0xf bank_mask:0xf
    v_fmac_f32_dpp v69, v69, v158 row_newbcast:15 row_mask:0xf bank_mask:0xf
    v_fmac_f32_dpp v70, v70, v158 row_newbcast:15 row_mask:0xf bank_mask:0xf
    v_fmac_f32_dpp v71, v71, v158 row_newbcast:15 row_mask:0xf bank_mask:0xf
    v_permlane16_swap_b32 v140, v142
    v_permlane16_swap_b32 v141, v143
    v_cvt_pk_bf16_f32 v144, v68, v69
    v_cvt_pk_bf16_f32 v145, v70, v71
    v_pk_max_i16 v144, v144, 0
    v_pk_max_i16 v145, v145, 0
    v_lshrrev_b32 v6, 5, v0
    v_and_b32 v7, 7, v0
    s_barrier
    v_xor_b32 v6, v6, v7
    v_lshlrev_b32 v6, 4, v6
    v_and_b32 v7, 15, v0
    v_lshl_add_u32 v6, v7, 7, v6
    v_bfe_u32 v7, v0, 4, 1
    v_lshl_add_u32 v6, v7, 3, v6
    s_sub_u32 s8, s47, 5
    s_lshl_b32 s8, s8, 1
    s_add_u32 s9, s4, 0
    s_cmp_lt_u32 s47, 5
    s_cselect_b32 s8, s47, s8
    s_cselect_b32 s10, s4, 8
    s_cselect_b32 s11, 1, 0
    s_add_u32 s9, s9, s10
    s_lshr_b32 s10, s9, 2
    s_barrier
    s_sub_u32 s10, s10, s101
    s_cselect_b32 s100, 9, 0
    s_add_u32 s10, s10, s100
    s_mul_i32 s10, s10, 5
    s_add_u32 s10, s10, s8
    s_lshl_b32 s10, s10, 11
    s_and_b32 s100, s9, 3
    s_lshl_b32 s100, s100, 5
    s_or_b32 s10, s10, s100
    v_xor_b32 v152, s10, v6
    s_add_u32 s9, s9, s11
    s_xor_b32 s11, s11, 1
    s_add_u32 s8, s8, s11
    s_lshr_b32 s10, s9, 2
    s_sub_u32 s10, s10, s101
    s_barrier
    s_cselect_b32 s100, 9, 0
    s_add_u32 s10, s10, s100
    s_mul_i32 s10, s10, 5
    s_add_u32 s10, s10, s8
    s_lshl_b32 s10, s10, 11
    s_and_b32 s100, s9, 3
    s_lshl_b32 s100, s100, 5
    s_or_b32 s10, s10, s100
    v_xor_b32 v162, s10, v6
    ds_read_b64 v[152:153], v152 offset:61440
    ds_read_b64 v[162:163], v162 offset:61440
    s_barrier
    s_barrier
    s_barrier
    v_subrev_u32 v4, 30720, v10
    v_xor_b32 v5, 64, v4
    ds_read_b64_tr_b16 v[72:73], v1 offset:12288
    ds_read_b64_tr_b16 v[74:75], v1 offset:12800
    ds_read_b64_tr_b16 v[76:77], v2 offset:12288
    ds_read_b64_tr_b16 v[78:79], v2 offset:12800
    ds_read_b64_tr_b16 v[80:81], v3 offset:12288
    ds_read_b64_tr_b16 v[82:83], v3 offset:12800
    ds_read_b128 v[96:99], v4 offset:30720
    ds_read_b128 v[100:103], v4 offset:32768
    ds_read_b128 v[104:107], v4 offset:34816
    ds_read_b128 v[108:111], v4 offset:36864
    s_mov_b32 s71, 8
    s_mov_b32 s69, 2
    s_setprio 2
.p2align 3
    s_waitcnt lgkmcnt(0)
    s_barrier
    v_mfma_f32_16x16x32_bf16 v[12:15], v[72:75], v[96:99], 0
    v_mfma_f32_16x16x32_bf16 v[16:19], v[76:79], v[96:99], 0
    v_mfma_f32_16x16x32_bf16 v[20:23], v[80:83], v[96:99], 0
    v_mfma_f32_16x16x32_bf16 v[32:35], v[80:83], v[100:103], 0
    ds_read_b128 v[112:115], v4 offset:38912
    v_mfma_f32_16x16x32_bf16 v[28:31], v[76:79], v[100:103], 0
    ds_read_b64_tr_b16 v[84:85], v1 offset:24576
    ds_read_b64_tr_b16 v[86:87], v1 offset:25088
    v_mfma_f32_16x16x32_bf16 v[24:27], v[72:75], v[100:103], 0
    ds_read_b128 v[96:99], v5 offset:30720
    s_waitcnt lgkmcnt(5)
    s_nop 0
    v_mfma_f32_16x16x32_bf16 v[36:39], v[72:75], v[104:107], 0
    ds_read_b64_tr_b16 v[88:89], v2 offset:24576
    ds_read_b64_tr_b16 v[90:91], v2 offset:25088
    v_mfma_f32_16x16x32_bf16 v[40:43], v[76:79], v[104:107], 0
    ds_read_b128 v[100:103], v5 offset:32768
    v_mfma_f32_16x16x32_bf16 v[44:47], v[80:83], v[104:107], 0
    s_waitcnt lgkmcnt(7)
    s_nop 0
    ds_read_b64_tr_b16 v[92:93], v3 offset:24576
    v_mfma_f32_16x16x32_bf16 v[56:59], v[80:83], v[108:111], 0
    ds_read_b64_tr_b16 v[94:95], v3 offset:25088
    ds_read_b128 v[104:107], v5 offset:34816
    v_mfma_f32_16x16x32_bf16 v[52:55], v[76:79], v[108:111], 0
    v_mfma_f32_16x16x32_bf16 v[48:51], v[72:75], v[108:111], 0
    s_waitcnt lgkmcnt(9)
    s_nop 0
    v_mfma_f32_16x16x32_bf16 v[60:63], v[72:75], v[112:115], 0
    ds_read_b128 v[108:111], v5 offset:36864
    v_mfma_f32_16x16x32_bf16 v[64:67], v[76:79], v[112:115], 0
    v_mfma_f32_16x16x32_bf16 v[68:71], v[80:83], v[112:115], 0
    s_waitcnt lgkmcnt(2)
    s_barrier
    s_branch L_a7
L_ret2:
    s_setprio 3
    ds_write_b128 v148, v[116:119] offset:0
    s_setprio 0
    v_fmac_f32_dpp v12, v60, v154 row_newbcast:15 row_mask:0xf bank_mask:0xf
    v_fmac_f32_dpp v13, v61, v154 row_newbcast:15 row_mask:0xf bank_mask:0xf
    v_fmac_f32_dpp v14, v62, v154 row_newbcast:15 row_mask:0xf bank_mask:0xf
    v_fmac_f32_dpp v15, v63, v154 row_newbcast:15 row_mask:0xf bank_mask:0xf
    v_cvt_pk_bf16_f32 v116, v12, v13
    v_cvt_pk_bf16_f32 v117, v14, v15
    v_pk_max_i16 v116, v116, 0
    v_pk_max_i16 v117, v117, 0
    v_fmac_f32_dpp v24, v60, v155 row_newbcast:15 row_mask:0xf bank_mask:0xf
    v_fmac_f32_dpp v25, v61, v155 row_newbcast:15 row_mask:0xf bank_mask:0xf
    v_fmac_f32_dpp v26, v62, v155 row_newbcast:15 row_mask:0xf bank_mask:0xf
    v_fmac_f32_dpp v27, v63, v155 row_newbcast:15 row_mask:0xf bank_mask:0xf
    v_cvt_pk_bf16_f32 v118, v24, v25
    v_cvt_pk_bf16_f32 v119, v26, v27
    s_barrier
    s_setprio 3
    ds_write_b128 v148, v[120:123] offset:4096
    ds_write_b64 v147, v[124:125] offset:8192
    s_setprio 0
    v_pk_max_i16 v118, v118, 0
    v_pk_max_i16 v119, v119, 0
    v_fmac_f32_dpp v36, v60, v156 row_newbcast:15 row_mask:0xf bank_mask:0xf
    v_fmac_f32_dpp v37, v61, v156 row_newbcast:15 row_mask:0xf bank_mask:0xf
    v_fmac_f32_dpp v38, v62, v156 row_newbcast:15 row_mask:0xf bank_mask:0xf
    v_fmac_f32_dpp v39, v63, v156 row_newbcast:15 row_mask:0xf bank_mask:0xf
    v_permlane16_swap_b32 v116, v118
    v_permlane16_swap_b32 v117, v119
    v_cvt_pk_bf16_f32 v120, v36, v37
    v_cvt_pk_bf16_f32 v121, v38, v39
    v_pk_max_i16 v120, v120, 0
    v_pk_max_i16 v121, v121, 0
    v_fmac_f32_dpp v48, v60, v157 row_newbcast:15 row_mask:0xf bank_mask:0xf
    v_fmac_f32_dpp v49, v61, v157 row_newbcast:15 row_mask:0xf bank_mask:0xf
    s_barrier
    s_setprio 3
    ds_write_b128 v148, v[126:129] offset:10240
    s_setprio 0
    v_fmac_f32_dpp v50, v62, v157 row_newbcast:15 row_mask:0xf bank_mask:0xf
    v_fmac_f32_dpp v51, v63, v157 row_newbcast:15 row_mask:0xf bank_mask:0xf
    v_cvt_pk_bf16_f32 v122, v48, v49
    v_cvt_pk_bf16_f32 v123, v50, v51
    v_pk_max_i16 v122, v122, 0
    v_pk_max_i16 v123, v123, 0
    v_fmac_f32_dpp v60, v60, v158 row_newbcast:15 row_mask:0xf bank_mask:0xf
    v_fmac_f32_dpp v61, v61, v158 row_newbcast:15 row_mask:0xf bank_mask:0xf
    v_fmac_f32_dpp v62, v62, v158 row_newbcast:15 row_mask:0xf bank_mask:0xf
    v_fmac_f32_dpp v63, v63, v158 row_newbcast:15 row_mask:0xf bank_mask:0xf
    v_permlane16_swap_b32 v120, v122
    v_permlane16_swap_b32 v121, v123
    v_cvt_pk_bf16_f32 v124, v60, v61
    v_cvt_pk_bf16_f32 v125, v62, v63
    s_barrier
    s_setprio 3
    ds_write_b128 v148, v[130:133] offset:14336
    ds_write_b64 v147, v[134:135] offset:18432
    s_setprio 0
    v_pk_max_i16 v124, v124, 0
    v_pk_max_i16 v125, v125, 0
    v_fmac_f32_dpp v16, v64, v154 row_newbcast:15 row_mask:0xf bank_mask:0xf
    v_fmac_f32_dpp v17, v65, v154 row_newbcast:15 row_mask:0xf bank_mask:0xf
    v_fmac_f32_dpp v18, v66, v154 row_newbcast:15 row_mask:0xf bank_mask:0xf
    v_fmac_f32_dpp v19, v67, v154 row_newbcast:15 row_mask:0xf bank_mask:0xf
    v_cvt_pk_bf16_f32 v126, v16, v17
    v_cvt_pk_bf16_f32 v127, v18, v19
    v_pk_max_i16 v126, v126, 0
    v_pk_max_i16 v127, v127, 0
    v_fmac_f32_dpp v28, v64, v155 row_newbcast:15 row_mask:0xf bank_mask:0xf
    v_fmac_f32_dpp v29, v65, v155 row_newbcast:15 row_mask:0xf bank_mask:0xf
    v_fmac_f32_dpp v30, v66, v155 row_newbcast:15 row_mask:0xf bank_mask:0xf
    v_fmac_f32_dpp v31, v67, v155 row_newbcast:15 row_mask:0xf bank_mask:0xf
    s_barrier
    s_setprio 3
    ds_write_b128 v148, v[136:139] offset:20480
    s_setprio 0
    v_cvt_pk_bf16_f32 v128, v28, v29
    v_cvt_pk_bf16_f32 v129, v30, v31
    v_pk_max_i16 v128, v128, 0
    v_pk_max_i16 v129, v129, 0
    v_fmac_f32_dpp v40, v64, v156 row_newbcast:15 row_mask:0xf bank_mask:0xf
    v_fmac_f32_dpp v41, v65, v156 row_newbcast:15 row_mask:0xf bank_mask:0xf
    v_fmac_f32_dpp v42, v66, v156 row_newbcast:15 row_mask:0xf bank_mask:0xf
    v_fmac_f32_dpp v43, v67, v156 row_newbcast:15 row_mask:0xf bank_mask:0xf
    v_permlane16_swap_b32 v126, v128
    v_permlane16_swap_b32 v127, v129
    v_cvt_pk_bf16_f32 v130, v40, v41
    v_cvt_pk_bf16_f32 v131, v42, v43
    v_pk_max_i16 v130, v130, 0
    v_pk_max_i16 v131, v131, 0
    s_waitcnt lgkmcnt(0)
    s_barrier
    s_setprio 3
    ds_write_b128 v148, v[140:143] offset:24576
    ds_write_b64 v147, v[144:145] offset:28672
    s_setprio 0
    v_fmac_f32_dpp v52, v64, v157 row_newbcast:15 row_mask:0xf bank_mask:0xf
    v_fmac_f32_dpp v53, v65, v157 row_newbcast:15 row_mask:0xf bank_mask:0xf
    v_fmac_f32_dpp v54, v66, v157 row_newbcast:15 row_mask:0xf bank_mask:0xf
    v_fmac_f32_dpp v55, v67, v157 row_newbcast:15 row_mask:0xf bank_mask:0xf
    v_cvt_pk_bf16_f32 v132, v52, v53
    v_cvt_pk_bf16_f32 v133, v54, v55
    v_pk_max_i16 v132, v132, 0
    v_pk_max_i16 v133, v133, 0
    v_fmac_f32_dpp v64, v64, v158 row_newbcast:15 row_mask:0xf bank_mask:0xf
    v_fmac_f32_dpp v65, v65, v158 row_newbcast:15 row_mask:0xf bank_mask:0xf
    v_fmac_f32_dpp v66, v66, v158 row_newbcast:15 row_mask:0xf bank_mask:0xf
    v_fmac_f32_dpp v67, v67, v158 row_newbcast:15 row_mask:0xf bank_mask:0xf
    v_permlane16_swap_b32 v130, v132
    v_permlane16_swap_b32 v131, v133
    s_barrier
    s_setprio 3
    ds_write_b128 v148, v[116:119] offset:30720
    s_setprio 0
    v_cvt_pk_bf16_f32 v134, v64, v65
    v_cvt_pk_bf16_f32 v135, v66, v67
    v_pk_max_i16 v134, v134, 0
    v_pk_max_i16 v135, v135, 0
    v_fmac_f32_dpp v20, v68, v154 row_newbcast:15 row_mask:0xf bank_mask:0xf
    v_fmac_f32_dpp v21, v69, v154 row_newbcast:15 row_mask:0xf bank_mask:0xf
    v_fmac_f32_dpp v22, v70, v154 row_newbcast:15 row_mask:0xf bank_mask:0xf
    v_fmac_f32_dpp v23, v71, v154 row_newbcast:15 row_mask:0xf bank_mask:0xf
    v_cvt_pk_bf16_f32 v136, v20, v21
    v_cvt_pk_bf16_f32 v137, v22, v23
    v_pk_max_i16 v136, v136, 0
    v_pk_max_i16 v137, v137, 0
    v_fmac_f32_dpp v32, v68, v155 row_newbcast:15 row_mask:0xf bank_mask:0xf
    v_fmac_f32_dpp v33, v69, v155 row_newbcast:15 row_mask:0xf bank_mask:0xf
    s_waitcnt lgkmcnt(0)
    s_barrier
    s_setprio 3
    ds_write_b128 v148, v[120:123] offset:34816
    s_setprio 0
    v_fmac_f32_dpp v34, v70, v155 row_newbcast:15 row_mask:0xf bank_mask:0xf
    v_fmac_f32_dpp v35, v71, v155 row_newbcast:15 row_mask:0xf bank_mask:0xf
    v_cvt_pk_bf16_f32 v138, v32, v33
    v_cvt_pk_bf16_f32 v139, v34, v35
    v_pk_max_i16 v138, v138, 0
    v_pk_max_i16 v139, v139, 0
    v_fmac_f32_dpp v44, v68, v156 row_newbcast:15 row_mask:0xf bank_mask:0xf
    v_fmac_f32_dpp v45, v69, v156 row_newbcast:15 row_mask:0xf bank_mask:0xf
    v_fmac_f32_dpp v46, v70, v156 row_newbcast:15 row_mask:0xf bank_mask:0xf
    v_fmac_f32_dpp v47, v71, v156 row_newbcast:15 row_mask:0xf bank_mask:0xf
    v_permlane16_swap_b32 v136, v138
    v_permlane16_swap_b32 v137, v139
    v_cvt_pk_bf16_f32 v140, v44, v45
    v_cvt_pk_bf16_f32 v141, v46, v47
    s_barrier
    s_setprio 3
    ds_write_b64 v147, v[124:125] offset:38912
    s_setprio 0
    v_pk_max_i16 v140, v140, 0
    v_pk_max_i16 v141, v141, 0
    v_fmac_f32_dpp v56, v68, v157 row_newbcast:15 row_mask:0xf bank_mask:0xf
    v_fmac_f32_dpp v57, v69, v157 row_newbcast:15 row_mask:0xf bank_mask:0xf
    v_fmac_f32_dpp v58, v70, v157 row_newbcast:15 row_mask:0xf bank_mask:0xf
    v_fmac_f32_dpp v59, v71, v157 row_newbcast:15 row_mask:0xf bank_mask:0xf
    v_cvt_pk_bf16_f32 v142, v56, v57
    v_cvt_pk_bf16_f32 v143, v58, v59
    v_pk_max_i16 v142, v142, 0
    v_pk_max_i16 v143, v143, 0
    v_fmac_f32_dpp v68, v68, v158 row_newbcast:15 row_mask:0xf bank_mask:0xf
    v_fmac_f32_dpp v69, v69, v158 row_newbcast:15 row_mask:0xf bank_mask:0xf
    v_fmac_f32_dpp v70, v70, v158 row_newbcast:15 row_mask:0xf bank_mask:0xf
    v_fmac_f32_dpp v71, v71, v158 row_newbcast:15 row_mask:0xf bank_mask:0xf
    s_waitcnt lgkmcnt(0)
    s_barrier
    s_setprio 3
    ds_write_b128 v148, v[126:129] offset:40960
    s_setprio 0
    v_permlane16_swap_b32 v140, v142
    v_permlane16_swap_b32 v141, v143
    v_cvt_pk_bf16_f32 v144, v68, v69
    v_cvt_pk_bf16_f32 v145, v70, v71
    v_pk_max_i16 v144, v144, 0
    v_pk_max_i16 v145, v145, 0
    v_lshrrev_b32 v6, 4, v0
    v_bfe_u32 v7, v0, 2, 2
    v_mul_u32_u24 v8, 24, v6
    v_add_lshl_u32 v8, v8, v7, 7
    v_and_b32 v9, 3, v0
    v_lshl_add_u32 v8, v9, 3, v8
    v_lshrrev_b32 v7, 1, v7
    v_and_b32 v9, 1, v6
    s_barrier
    s_setprio 3
    ds_write_b128 v148, v[130:133] offset:45056
    s_setprio 0
    v_lshl_or_b32 v7, v9, 1, v7
    s_mul_i32 s8, s4, 2
    s_add_u32 s8, s8, 0
    s_and_b32 s9, s8, 3
    s_lshr_b32 s8, s8, 2
    s_lshl_b32 s8, s8, 10
    v_xor_b32 v9, s9, v7
    v_lshl_add_u32 v1, v9, 5, v8
    v_add_u32 v1, s8, v1
    s_mul_i32 s8, s4, 2
    s_add_u32 s8, s8, 1
    s_and_b32 s9, s8, 3
    s_lshr_b32 s8, s8, 2
    s_lshl_b32 s8, s8, 10
    s_waitcnt lgkmcnt(0)
    s_barrier
    s_setprio 3
    ds_write_b64 v147, v[134:135] offset:49152
    s_setprio 0
    v_xor_b32 v9, s9, v7
    v_lshl_add_u32 v2, v9, 5, v8
    v_add_u32 v2, s8, v2
    s_mul_i32 s8, s4, 1
    s_add_u32 s8, s8, 8
    s_and_b32 s9, s8, 3
    s_lshr_b32 s8, s8, 2
    s_lshl_b32 s8, s8, 10
    v_xor_b32 v9, s9, v7
    v_lshl_add_u32 v3, v9, 5, v8
    v_add_u32 v3, s8, v3
    s_mul_i32 s8, s46, 1536
    s_mul_i32 s9, s4, 128
    s_add_u32 s8, s8, s9
    s_barrier
    s_setprio 3
    ds_write_b128 v148, v[136:139] offset:51200
    s_setprio 0
    s_lshl_b32 s9, s47, 2
    s_add_u32 s8, s8, s9
    s_add_u32 s72, s8, 29360128
    s_waitcnt lgkmcnt(0)
    s_barrier
    s_setprio 3
    ds_write_b128 v148, v[140:143] offset:55296
    s_setprio 0
    s_barrier
    s_setprio 3
    ds_write_b64 v147, v[144:145] offset:59392
    s_setprio 0
    s_waitcnt lgkmcnt(0)
    s_barrier
    s_barrier
    s_barrier
    v_subrev_u32 v4, 10240, v10
    v_xor_b32 v5, 64, v4
    ds_read_b64_tr_b16 v[72:73], v1 offset:24576
    ds_read_b64_tr_b16 v[74:75], v1 offset:25088
    ds_read_b64_tr_b16 v[76:77], v2 offset:24576
    ds_read_b64_tr_b16 v[78:79], v2 offset:25088
    ds_read_b64_tr_b16 v[80:81], v3 offset:24576
    ds_read_b64_tr_b16 v[82:83], v3 offset:25088
    ds_read_b128 v[96:99], v4 offset:10240
    ds_read_b128 v[100:103], v4 offset:12288
    ds_read_b128 v[104:107], v4 offset:14336
    ds_read_b128 v[108:111], v4 offset:16384
    s_mov_b32 s71, 8
    s_mov_b32 s69, 4
    s_setprio 2
.p2align 3
    s_waitcnt lgkmcnt(0)
    s_barrier
    v_mfma_f32_16x16x32_bf16 v[12:15], v[72:75], v[96:99], 0
    v_mfma_f32_16x16x32_bf16 v[16:19], v[76:79], v[96:99], 0
    v_mfma_f32_16x16x32_bf16 v[20:23], v[80:83], v[96:99], 0
    v_mfma_f32_16x16x32_bf16 v[32:35], v[80:83], v[100:103], 0
    ds_read_b128 v[112:115], v4 offset:18432
    v_mfma_f32_16x16x32_bf16 v[28:31], v[76:79], v[100:103], 0
    ds_read_b64_tr_b16 v[84:85], v1 offset:36864
    ds_read_b64_tr_b16 v[86:87], v1 offset:37376
    v_mfma_f32_16x16x32_bf16 v[24:27], v[72:75], v[100:103], 0
    ds_read_b128 v[96:99], v5 offset:10240
    s_waitcnt lgkmcnt(5)
    s_nop 0
    v_mfma_f32_16x16x32_bf16 v[36:39], v[72:75], v[104:107], 0
    ds_read_b64_tr_b16 v[88:89], v2 offset:36864
    ds_read_b64_tr_b16 v[90:91], v2 offset:37376
    v_mfma_f32_16x16x32_bf16 v[40:43], v[76:79], v[104:107], 0
    ds_read_b128 v[100:103], v5 offset:12288
    v_mfma_f32_16x16x32_bf16 v[44:47], v[80:83], v[104:107], 0
    s_waitcnt lgkmcnt(7)
    s_nop 0
    ds_read_b64_tr_b16 v[92:93], v3 offset:36864
    v_mfma_f32_16x16x32_bf16 v[56:59], v[80:83], v[108:111], 0
    ds_read_b64_tr_b16 v[94:95], v3 offset:37376
    ds_read_b128 v[104:107], v5 offset:14336
    v_mfma_f32_16x16x32_bf16 v[52:55], v[76:79], v[108:111], 0
    v_mfma_f32_16x16x32_bf16 v[48:51], v[72:75], v[108:111], 0
    s_waitcnt lgkmcnt(9)
    s_nop 0
    v_mfma_f32_16x16x32_bf16 v[60:63], v[72:75], v[112:115], 0
    ds_read_b128 v[108:111], v5 offset:16384
    v_mfma_f32_16x16x32_bf16 v[64:67], v[76:79], v[112:115], 0
    v_mfma_f32_16x16x32_bf16 v[68:71], v[80:83], v[112:115], 0
    s_waitcnt lgkmcnt(2)
    s_barrier
    s_branch L_a3
L_ret4:
    v_lshlrev_b32 v150, 4, v0
    s_lshl_b32 s8, s4, 10
    s_add_u32 s8, s8, 157696
    v_add_u32 v159, s8, v150
    v_add_u32 v150, 262144, v150
    v_cvt_pk_bf16_f32 v116, v12, v13
    v_cvt_pk_bf16_f32 v117, v14, v15
    v_cvt_pk_bf16_f32 v118, v16, v17
    v_cvt_pk_bf16_f32 v119, v18, v19
    v_cvt_pk_bf16_f32 v136, v20, v21
    v_cvt_pk_bf16_f32 v137, v22, v23
    v_cvt_pk_bf16_f32 v120, v24, v25
    v_cvt_pk_bf16_f32 v121, v26, v27
    v_cvt_pk_bf16_f32 v122, v28, v29
    v_cvt_pk_bf16_f32 v123, v30, v31
    v_cvt_pk_bf16_f32 v138, v32, v33
    v_cvt_pk_bf16_f32 v139, v34, v35
    v_cvt_pk_bf16_f32 v124, v36, v37
    v_cvt_pk_bf16_f32 v125, v38, v39
    v_cvt_pk_bf16_f32 v126, v40, v41
    v_cvt_pk_bf16_f32 v127, v42, v43
    s_barrier
    buffer_store_dwordx4 v[116:119], v150, s[60:63], s32 offen sc0 sc1
    v_cvt_pk_bf16_f32 v140, v44, v45
    v_cvt_pk_bf16_f32 v141, v46, v47
    v_cvt_pk_bf16_f32 v128, v48, v49
    v_cvt_pk_bf16_f32 v129, v50, v51
    v_cvt_pk_bf16_f32 v130, v52, v53
    v_cvt_pk_bf16_f32 v131, v54, v55
    v_cvt_pk_bf16_f32 v142, v56, v57
    v_cvt_pk_bf16_f32 v143, v58, v59
    v_cvt_pk_bf16_f32 v132, v60, v61
    v_cvt_pk_bf16_f32 v133, v62, v63
    v_cvt_pk_bf16_f32 v134, v64, v65
    v_cvt_pk_bf16_f32 v135, v66, v67
    v_cvt_pk_bf16_f32 v144, v68, v69
    v_cvt_pk_bf16_f32 v145, v70, v71
    s_lshl_b32 s8, s47, 2
    s_set_gpr_idx_on s8, gpr_idx(SRC0)
    v_mov_b32 v164, v116
    v_mov_b32 v165, v117
    v_mov_b32 v166, v118
    v_mov_b32 v167, v119
    s_set_gpr_idx_off
    v_permlane32_swap_b32 v144, v146
    v_permlane32_swap_b32 v145, v147
    s_lshl_b32 s79, s3, 10
    s_add_u32 s79, s79, 36864
    s_mul_i32 s74, s46, 12
    s_mov_b32 s78, 4
    s_add_u32 s74, s74, s4
    s_add_u32 s74, s74, 0
    s_barrier
    s_mov_b32 s75, s47
    s_mov_b32 s25, 153600
    s_mov_b32 s77, 0
    s_mov_b32 s77, 0
    s_mul_i32 s7, s74, 128
    s_add_u32 s7, s7, 29360128
    v_cmp_gt_u32 vcc, 8, v0
    v_mov_b32 v161, s78
    v_xor_b32 v7, s47, v0
    v_cndmask_b32 v7, v0, v7, vcc
    v_lshlrev_b32 v7, 2, v7
    v_cndmask_b32 v161, 1, v161, vcc
    s_lshl_b32 s8, s4, 10
    s_add_u32 s8, s8, s25
    v_lshl_add_u32 v76, v0, 4, s8
    s_mul_i32 s27, s74, 0x1556
    s_lshr_b32 s27, s27, 16
    s_mul_i32 s28, s27, 12
    s_sub_u32 s28, s74, s28
    s_mul_i32 s27, s27, 79
    s_and_b32 s29, s28, 3
    s_barrier
    buffer_store_dwordx4 v[120:123], v150, s[60:63], s33 offen sc0 sc1
    s_lshr_b32 s28, s28, 2
    s_mul_i32 s28, s28, 12
    s_add_u32 s28, s28, s29
    s_lshl_b32 s28, s28, 2
    s_lshl_b32 s29, s29, 2
    s_mul_i32 s10, s74, 65536
    v_and_b32 v2, 15, v0
    v_lshrrev_b32 v3, 4, v0
    s_bfe_u32 s6, s75, 196608
    s_mul_i32 s12, s6, 8192
    s_cmp_eq_u32 s6, 7
    s_cselect_b32 s11, 504, 0
    v_lshrrev_b32 v4, 5, v0
    v_mul_u32_u24 v4, s11, v4
    v_lshlrev_b32 v74, 4, v0
    v_sub_u32 v74, v74, v4
    s_cselect_b32 s11, 496, -1
    v_min_u32 v74, s11, v74
    v_add_u32 v74, s12, v74
    s_sub_u32 s12, s6, 5
    s_lshl_b32 s12, s12, 1
    s_barrier
    s_setprio 3
    ds_write_b128 v159, v[164:167]
    s_setprio 0
    s_cmp_lt_u32 s6, 5
    s_cselect_b32 s13, s6, s12
    s_cselect_b32 s14, 0, 128
    s_cselect_b32 s15, s29, 32
    s_cselect_b32 s18, 65536, 0
    s_cselect_b32 s19, 2, 1
    s_cselect_b32 s20, 3, 1
    s_cselect_b32 s26, 32, 512
    s_lshl_b32 s13, s13, 4
    s_add_u32 s9, s28, s15
    v_lshrrev_b32 v4, s19, v0
    v_add_u32 v4, s13, v4
    v_and_b32 v5, s20, v0
    v_add_u32 v6, s27, v4
    v_mul_u32_u24 v44, 1152, v6
    s_lshl_b32 s12, s9, 3
    v_lshl_add_u32 v5, v5, 4, s12
    v_add_u32 v44, v44, v5
    v_cmp_lt_u32 vcc, 78, v4
    v_mov_b32 v6, 0x8000000
    s_add_u32 s12, s79, 0
    s_barrier
    buffer_store_dwordx4 v[136:139], v150, s[60:63], s37 offen sc0 sc1
    v_lshl_add_u32 v45, v0, 4, s12
    v_cndmask_b32 v44, v44, v6, vcc
    s_add_u32 s19, s19, 4
    v_lshlrev_b32 v4, s19, v2
    v_lshl_add_u32 v4, v3, 3, v4
    v_add_u32 v72, s12, v4
    v_add_u32 v73, s26, v72
    s_add_u32 s8, s27, s13
    v_add_lshl_u32 v60, v2, s8, 3
    v_add_u32 v61, s14, v60
    v_min_u32 v60, 16376, v60
    v_min_u32 v61, 16376, v61
    v_add_lshl_u32 v5, v3, s9, 14
    v_add_u32 v62, v5, v60
    v_add3_u32 v63, v5, v61, s18
    s_mov_b32 s21, 20971520
    s_mov_b32 s22, 25165824
    s_mov_b32 s23, 0
    s_mov_b64 exec, 0xfffff
    buffer_load_dword v160, v7, s[60:63], s7 offen sc0 sc1
    s_mov_b64 exec, -1
    s_barrier
    s_barrier
    buffer_store_dwordx4 v[124:127], v150, s[60:63], s34 offen sc0 sc1
    s_barrier
    s_waitcnt vmcnt(1) lgkmcnt(0)
    v_cmp_le_u32 vcc, v161, v160
    s_andn2_b32 s12, 0xffffe, vcc_lo
    s_cselect_b32 s23, 1, 0x1ff
    s_cselect_b32 s15, 0x40000000, 0
    s_add_u32 s12, s10, s15
    s_add_u32 s13, s12, 4096
    s_add_u32 s14, s21, s15
    s_add_u32 s15, s22, s15
    s_mov_b32 s24, 0x1ff
    ds_read_b128 v[8:11], v76
    buffer_load_dwordx4 v[12:15], v74, s[60:63], s12 offen offset:1024 sc0 sc1
    s_barrier
    buffer_store_dwordx4 v[128:131], v150, s[60:63], s35 offen sc0 sc1
    buffer_load_dwordx4 v[16:19], v74, s[60:63], s12 offen offset:2048 sc0 sc1
    s_barrier
    buffer_load_dwordx4 v[20:23], v74, s[60:63], s12 offen offset:3072 sc0 sc1
    buffer_load_dwordx4 v[24:27], v74, s[60:63], s13 offen offset:0 sc0 sc1
    s_barrier
    buffer_store_dwordx4 v[140:143], v150, s[60:63], s38 offen sc0 sc1
    buffer_load_dwordx4 v[28:31], v74, s[60:63], s13 offen offset:1024 sc0 sc1
    s_barrier
    buffer_load_dwordx4 v[32:35], v74, s[60:63], s13 offen offset:2048 sc0 sc1
    buffer_load_dwordx4 v[36:39], v74, s[60:63], s13 offen offset:3072 sc0 sc1
    s_barrier
    buffer_store_dwordx4 v[132:135], v150, s[60:63], s36 offen sc0 sc1
    buffer_load_dwordx2 v[56:57], v62, s[60:63], s14 offen sc0 sc1
    s_barrier
    buffer_load_dword v46, v60, s[60:63], s15 offen sc0 sc1
    buffer_load_dwordx2 v[58:59], v63, s[60:63], s14 offen sc0 sc1
    s_barrier
    s_mov_b32 exec_hi, 0
    buffer_store_dwordx4 v[144:147], v150, s[60:63], s39 offen sc0 sc1
    s_mov_b32 exec_hi, -1
    buffer_load_dword v47, v61, s[60:63], s15 offen sc0 sc1
    s_barrier
    v_mov_b32 v6, 4
    s_add_u32 s8, s72, 512
    s_mov_b64 exec, 1
    s_waitcnt vmcnt(0) lgkmcnt(0)
    buffer_store_dword v6, off, s[60:63], s8 sc0 sc1
    s_mov_b64 exec, -1
    s_cmp_lg_u32 s23, 0x1ff
    s_cbranch_scc1 L_red1_mid
    s_mov_b32 s56, s40
    s_and_b32 s57, s41, 0xffff
    s_mov_b32 s58, 2359296
    s_mov_b32 s59, 0x20000
    s_waitcnt lgkmcnt(0)
    v_lshlrev_b32 v64, 16, v152
    v_and_b32 v65, 0xffff0000, v152
    v_lshlrev_b32 v66, 16, v153
    v_and_b32 v67, 0xffff0000, v153
    v_lshlrev_b32 v68, 16, v162
    v_and_b32 v69, 0xffff0000, v162
    v_lshlrev_b32 v70, 16, v163
    v_and_b32 v71, 0xffff0000, v163
    s_branch L_red1_go2
.p2align 6
L_a0:
    v_mfma_f32_16x16x32_bf16 v[12:15], v[72:75], v[96:99], v[12:15]
    v_mfma_f32_16x16x32_bf16 v[16:19], v[76:79], v[96:99], v[16:19]
    v_mfma_f32_16x16x32_bf16 v[20:23], v[80:83], v[96:99], v[20:23]
    v_mfma_f32_16x16x32_bf16 v[32:35], v[80:83], v[100:103], v[32:35]
    ds_read_b128 v[112:115], v4 offset:8192
    v_mfma_f32_16x16x32_bf16 v[28:31], v[76:79], v[100:103], v[28:31]
    ds_read_b64_tr_b16 v[84:85], v1 offset:12288
    ds_read_b64_tr_b16 v[86:87], v1 offset:12800
    v_mfma_f32_16x16x32_bf16 v[24:27], v[72:75], v[100:103], v[24:27]
    ds_read_b128 v[96:99], v5 offset:0
    s_waitcnt lgkmcnt(5)
    s_nop 0
    v_mfma_f32_16x16x32_bf16 v[36:39], v[72:75], v[104:107], v[36:39]
    ds_read_b64_tr_b16 v[88:89], v2 offset:12288
    ds_read_b64_tr_b16 v[90:91], v2 offset:12800
    v_mfma_f32_16x16x32_bf16 v[40:43], v[76:79], v[104:107], v[40:43]
    ds_read_b128 v[100:103], v5 offset:2048
    v_mfma_f32_16x16x32_bf16 v[44:47], v[80:83], v[104:107], v[44:47]
    s_waitcnt lgkmcnt(7)
    s_nop 0
    ds_read_b64_tr_b16 v[92:93], v3 offset:12288
    v_mfma_f32_16x16x32_bf16 v[56:59], v[80:83], v[108:111], v[56:59]
    ds_read_b64_tr_b16 v[94:95], v3 offset:12800
    ds_read_b128 v[104:107], v5 offset:4096
    v_mfma_f32_16x16x32_bf16 v[52:55], v[76:79], v[108:111], v[52:55]
    s_sub_u32 s71, s71, 1
    s_cmp_eq_u32 s71, 0
    v_mfma_f32_16x16x32_bf16 v[48:51], v[72:75], v[108:111], v[48:51]
    s_waitcnt lgkmcnt(9)
    s_nop 0
    v_mfma_f32_16x16x32_bf16 v[60:63], v[72:75], v[112:115], v[60:63]
    ds_read_b128 v[108:111], v5 offset:6144
    v_mfma_f32_16x16x32_bf16 v[64:67], v[76:79], v[112:115], v[64:67]
    v_mfma_f32_16x16x32_bf16 v[68:71], v[80:83], v[112:115], v[68:71]
    s_waitcnt lgkmcnt(2)
    s_barrier
    s_cbranch_scc1 L_tail
    s_nop 0
L_a1:
    v_mfma_f32_16x16x32_bf16 v[12:15], v[84:87], v[96:99], v[12:15]
    v_mfma_f32_16x16x32_bf16 v[16:19], v[88:91], v[96:99], v[16:19]
    v_mfma_f32_16x16x32_bf16 v[20:23], v[92:95], v[96:99], v[20:23]
    v_mfma_f32_16x16x32_bf16 v[32:35], v[92:95], v[100:103], v[32:35]
    ds_read_b128 v[112:115], v5 offset:8192
    v_mfma_f32_16x16x32_bf16 v[28:31], v[88:91], v[100:103], v[28:31]
    ds_read_b64_tr_b16 v[72:73], v1 offset:24576
    ds_read_b64_tr_b16 v[74:75], v1 offset:25088
    v_mfma_f32_16x16x32_bf16 v[24:27], v[84:87], v[100:103], v[24:27]
    ds_read_b128 v[96:99], v4 offset:10240
    s_waitcnt lgkmcnt(5)
    s_nop 0
    v_mfma_f32_16x16x32_bf16 v[36:39], v[84:87], v[104:107], v[36:39]
    ds_read_b64_tr_b16 v[76:77], v2 offset:24576
    ds_read_b64_tr_b16 v[78:79], v2 offset:25088
    v_mfma_f32_16x16x32_bf16 v[40:43], v[88:91], v[104:107], v[40:43]
    ds_read_b128 v[100:103], v4 offset:12288
    v_mfma_f32_16x16x32_bf16 v[44:47], v[92:95], v[104:107], v[44:47]
    s_waitcnt lgkmcnt(7)
    s_nop 0
    ds_read_b64_tr_b16 v[80:81], v3 offset:24576
    v_mfma_f32_16x16x32_bf16 v[56:59], v[92:95], v[108:111], v[56:59]
    ds_read_b64_tr_b16 v[82:83], v3 offset:25088
    ds_read_b128 v[104:107], v4 offset:14336
    v_mfma_f32_16x16x32_bf16 v[52:55], v[88:91], v[108:111], v[52:55]
    v_mfma_f32_16x16x32_bf16 v[48:51], v[84:87], v[108:111], v[48:51]
    s_waitcnt lgkmcnt(9)
    s_nop 0
    v_mfma_f32_16x16x32_bf16 v[60:63], v[84:87], v[112:115], v[60:63]
    ds_read_b128 v[108:111], v4 offset:16384
    v_mfma_f32_16x16x32_bf16 v[64:67], v[88:91], v[112:115], v[64:67]
    v_mfma_f32_16x16x32_bf16 v[68:71], v[92:95], v[112:115], v[68:71]
    s_waitcnt lgkmcnt(2)
    s_barrier
L_a2:
    v_mfma_f32_16x16x32_bf16 v[12:15], v[72:75], v[96:99], v[12:15]
    v_mfma_f32_16x16x32_bf16 v[16:19], v[76:79], v[96:99], v[16:19]
    v_mfma_f32_16x16x32_bf16 v[20:23], v[80:83], v[96:99], v[20:23]
    v_mfma_f32_16x16x32_bf16 v[32:35], v[80:83], v[100:103], v[32:35]
    ds_read_b128 v[112:115], v4 offset:18432
    v_mfma_f32_16x16x32_bf16 v[28:31], v[76:79], v[100:103], v[28:31]
    ds_read_b64_tr_b16 v[84:85], v1 offset:36864
    ds_read_b64_tr_b16 v[86:87], v1 offset:37376
    v_mfma_f32_16x16x32_bf16 v[24:27], v[72:75], v[100:103], v[24:27]
    ds_read_b128 v[96:99], v5 offset:10240
    s_waitcnt lgkmcnt(5)
    s_nop 0
    v_mfma_f32_16x16x32_bf16 v[36:39], v[72:75], v[104:107], v[36:39]
    ds_read_b64_tr_b16 v[88:89], v2 offset:36864
    ds_read_b64_tr_b16 v[90:91], v2 offset:37376
    v_mfma_f32_16x16x32_bf16 v[40:43], v[76:79], v[104:107], v[40:43]
    ds_read_b128 v[100:103], v5 offset:12288
    v_mfma_f32_16x16x32_bf16 v[44:47], v[80:83], v[104:107], v[44:47]
    s_waitcnt lgkmcnt(7)
    s_nop 0
    ds_read_b64_tr_b16 v[92:93], v3 offset:36864
    v_mfma_f32_16x16x32_bf16 v[56:59], v[80:83], v[108:111], v[56:59]
    ds_read_b64_tr_b16 v[94:95], v3 offset:37376
    ds_read_b128 v[104:107], v5 offset:14336
    v_mfma_f32_16x16x32_bf16 v[52:55], v[76:79], v[108:111], v[52:55]
    s_sub_u32 s71, s71, 1
    s_cmp_eq_u32 s71, 0
    v_mfma_f32_16x16x32_bf16 v[48:51], v[72:75], v[108:111], v[48:51]
    s_waitcnt lgkmcnt(9)
    s_nop 0
    v_mfma_f32_16x16x32_bf16 v[60:63], v[72:75], v[112:115], v[60:63]
    ds_read_b128 v[108:111], v5 offset:16384
    v_mfma_f32_16x16x32_bf16 v[64:67], v[76:79], v[112:115], v[64:67]
    v_mfma_f32_16x16x32_bf16 v[68:71], v[80:83], v[112:115], v[68:71]
    s_waitcnt lgkmcnt(2)
    s_barrier
    s_cbranch_scc1 L_tail
    s_nop 0
L_a3:
    v_mfma_f32_16x16x32_bf16 v[12:15], v[84:87], v[96:99], v[12:15]
    v_mfma_f32_16x16x32_bf16 v[16:19], v[88:91], v[96:99], v[16:19]
    v_mfma_f32_16x16x32_bf16 v[20:23], v[92:95], v[96:99], v[20:23]
    v_mfma_f32_16x16x32_bf16 v[32:35], v[92:95], v[100:103], v[32:35]
    ds_read_b128 v[112:115], v5 offset:18432
    v_mfma_f32_16x16x32_bf16 v[28:31], v[88:91], v[100:103], v[28:31]
    ds_read_b64_tr_b16 v[72:73], v1 offset:49152
    ds_read_b64_tr_b16 v[74:75], v1 offset:49664
    v_mfma_f32_16x16x32_bf16 v[24:27], v[84:87], v[100:103], v[24:27]
    ds_read_b128 v[96:99], v4 offset:20480
    s_waitcnt lgkmcnt(5)
    s_nop 0
    v_mfma_f32_16x16x32_bf16 v[36:39], v[84:87], v[104:107], v[36:39]
    ds_read_b64_tr_b16 v[76:77], v2 offset:49152
    ds_read_b64_tr_b16 v[78:79], v2 offset:49664
    v_mfma_f32_16x16x32_bf16 v[40:43], v[88:91], v[104:107], v[40:43]
    ds_read_b128 v[100:103], v4 offset:22528
    v_mfma_f32_16x16x32_bf16 v[44:47], v[92:95], v[104:107], v[44:47]
    s_waitcnt lgkmcnt(7)
    s_nop 0
    ds_read_b64_tr_b16 v[80:81], v3 offset:49152
    v_mfma_f32_16x16x32_bf16 v[56:59], v[92:95], v[108:111], v[56:59]
    ds_read_b64_tr_b16 v[82:83], v3 offset:49664
    ds_read_b128 v[104:107], v4 offset:24576
    v_mfma_f32_16x16x32_bf16 v[52:55], v[88:91], v[108:111], v[52:55]
    v_mfma_f32_16x16x32_bf16 v[48:51], v[84:87], v[108:111], v[48:51]
    s_waitcnt lgkmcnt(9)
    s_nop 0
    v_mfma_f32_16x16x32_bf16 v[60:63], v[84:87], v[112:115], v[60:63]
    ds_read_b128 v[108:111], v4 offset:26624
    v_mfma_f32_16x16x32_bf16 v[64:67], v[88:91], v[112:115], v[64:67]
    v_mfma_f32_16x16x32_bf16 v[68:71], v[92:95], v[112:115], v[68:71]
    s_waitcnt lgkmcnt(2)
    s_barrier
L_a4:
    v_mfma_f32_16x16x32_bf16 v[12:15], v[72:75], v[96:99], v[12:15]
    v_mfma_f32_16x16x32_bf16 v[16:19], v[76:79], v[96:99], v[16:19]
    v_mfma_f32_16x16x32_bf16 v[20:23], v[80:83], v[96:99], v[20:23]
    v_mfma_f32_16x16x32_bf16 v[32:35], v[80:83], v[100:103], v[32:35]
    ds_read_b128 v[112:115], v4 offset:28672
    v_mfma_f32_16x16x32_bf16 v[28:31], v[76:79], v[100:103], v[28:31]
    ds_read_b64_tr_b16 v[84:85], v1 offset:0
    ds_read_b64_tr_b16 v[86:87], v1 offset:512
    v_mfma_f32_16x16x32_bf16 v[24:27], v[72:75], v[100:103], v[24:27]
    ds_read_b128 v[96:99], v5 offset:20480
    s_waitcnt lgkmcnt(5)
    s_nop 0
    v_mfma_f32_16x16x32_bf16 v[36:39], v[72:75], v[104:107], v[36:39]
    ds_read_b64_tr_b16 v[88:89], v2 offset:0
    ds_read_b64_tr_b16 v[90:91], v2 offset:512
    v_mfma_f32_16x16x32_bf16 v[40:43], v[76:79], v[104:107], v[40:43]
    ds_read_b128 v[100:103], v5 offset:22528
    v_mfma_f32_16x16x32_bf16 v[44:47], v[80:83], v[104:107], v[44:47]
    s_waitcnt lgkmcnt(7)
    s_nop 0
    ds_read_b64_tr_b16 v[92:93], v3 offset:0
    v_mfma_f32_16x16x32_bf16 v[56:59], v[80:83], v[108:111], v[56:59]
    ds_read_b64_tr_b16 v[94:95], v3 offset:512
    ds_read_b128 v[104:107], v5 offset:24576
    v_mfma_f32_16x16x32_bf16 v[52:55], v[76:79], v[108:111], v[52:55]
    s_sub_u32 s71, s71, 1
    s_cmp_eq_u32 s71, 0
    v_mfma_f32_16x16x32_bf16 v[48:51], v[72:75], v[108:111], v[48:51]
    s_waitcnt lgkmcnt(9)
    s_nop 0
    v_mfma_f32_16x16x32_bf16 v[60:63], v[72:75], v[112:115], v[60:63]
    ds_read_b128 v[108:111], v5 offset:26624
    v_mfma_f32_16x16x32_bf16 v[64:67], v[76:79], v[112:115], v[64:67]
    v_mfma_f32_16x16x32_bf16 v[68:71], v[80:83], v[112:115], v[68:71]
    s_waitcnt lgkmcnt(2)
    s_barrier
    s_cbranch_scc1 L_tail
    s_nop 0
L_a5:
    v_mfma_f32_16x16x32_bf16 v[12:15], v[84:87], v[96:99], v[12:15]
    v_mfma_f32_16x16x32_bf16 v[16:19], v[88:91], v[96:99], v[16:19]
    v_mfma_f32_16x16x32_bf16 v[20:23], v[92:95], v[96:99], v[20:23]
    v_mfma_f32_16x16x32_bf16 v[32:35], v[92:95], v[100:103], v[32:35]
    ds_read_b128 v[112:115], v5 offset:28672
    v_mfma_f32_16x16x32_bf16 v[28:31], v[88:91], v[100:103], v[28:31]
    ds_read_b64_tr_b16 v[72:73], v1 offset:12288
    ds_read_b64_tr_b16 v[74:75], v1 offset:12800
    v_mfma_f32_16x16x32_bf16 v[24:27], v[84:87], v[100:103], v[24:27]
    ds_read_b128 v[96:99], v4 offset:30720
    s_waitcnt lgkmcnt(5)
    s_nop 0
    v_mfma_f32_16x16x32_bf16 v[36:39], v[84:87], v[104:107], v[36:39]
    ds_read_b64_tr_b16 v[76:77], v2 offset:12288
    ds_read_b64_tr_b16 v[78:79], v2 offset:12800
    v_mfma_f32_16x16x32_bf16 v[40:43], v[88:91], v[104:107], v[40:43]
    ds_read_b128 v[100:103], v4 offset:32768
    v_mfma_f32_16x16x32_bf16 v[44:47], v[92:95], v[104:107], v[44:47]
    s_waitcnt lgkmcnt(7)
    s_nop 0
    ds_read_b64_tr_b16 v[80:81], v3 offset:12288
    v_mfma_f32_16x16x32_bf16 v[56:59], v[92:95], v[108:111], v[56:59]
    ds_read_b64_tr_b16 v[82:83], v3 offset:12800
    ds_read_b128 v[104:107], v4 offset:34816
    v_mfma_f32_16x16x32_bf16 v[52:55], v[88:91], v[108:111], v[52:55]
    v_mfma_f32_16x16x32_bf16 v[48:51], v[84:87], v[108:111], v[48:51]
    s_waitcnt lgkmcnt(9)
    s_nop 0
    v_mfma_f32_16x16x32_bf16 v[60:63], v[84:87], v[112:115], v[60:63]
    ds_read_b128 v[108:111], v4 offset:36864
    v_mfma_f32_16x16x32_bf16 v[64:67], v[88:91], v[112:115], v[64:67]
    v_mfma_f32_16x16x32_bf16 v[68:71], v[92:95], v[112:115], v[68:71]
    s_waitcnt lgkmcnt(2)
    s_barrier
L_a6:
    v_mfma_f32_16x16x32_bf16 v[12:15], v[72:75], v[96:99], v[12:15]
    v_mfma_f32_16x16x32_bf16 v[16:19], v[76:79], v[96:99], v[16:19]
    v_mfma_f32_16x16x32_bf16 v[20:23], v[80:83], v[96:99], v[20:23]
    v_mfma_f32_16x16x32_bf16 v[32:35], v[80:83], v[100:103], v[32:35]
    ds_read_b128 v[112:115], v4 offset:38912
    v_mfma_f32_16x16x32_bf16 v[28:31], v[76:79], v[100:103], v[28:31]
    ds_read_b64_tr_b16 v[84:85], v1 offset:24576
    ds_read_b64_tr_b16 v[86:87], v1 offset:25088
    v_mfma_f32_16x16x32_bf16 v[24:27], v[72:75], v[100:103], v[24:27]
    ds_read_b128 v[96:99], v5 offset:30720
    s_waitcnt lgkmcnt(5)
    s_nop 0
    v_mfma_f32_16x16x32_bf16 v[36:39], v[72:75], v[104:107], v[36:39]
    ds_read_b64_tr_b16 v[88:89], v2 offset:24576
    ds_read_b64_tr_b16 v[90:91], v2 offset:25088
    v_mfma_f32_16x16x32_bf16 v[40:43], v[76:79], v[104:107], v[40:43]
    ds_read_b128 v[100:103], v5 offset:32768
    v_mfma_f32_16x16x32_bf16 v[44:47], v[80:83], v[104:107], v[44:47]
    s_waitcnt lgkmcnt(7)
    s_nop 0
    ds_read_b64_tr_b16 v[92:93], v3 offset:24576
    v_mfma_f32_16x16x32_bf16 v[56:59], v[80:83], v[108:111], v[56:59]
    ds_read_b64_tr_b16 v[94:95], v3 offset:25088
    ds_read_b128 v[104:107], v5 offset:34816
    v_mfma_f32_16x16x32_bf16 v[52:55], v[76:79], v[108:111], v[52:55]
    s_sub_u32 s71, s71, 1
    s_cmp_eq_u32 s71, 0
    v_mfma_f32_16x16x32_bf16 v[48:51], v[72:75], v[108:111], v[48:51]
    s_waitcnt lgkmcnt(9)
    s_nop 0
    v_mfma_f32_16x16x32_bf16 v[60:63], v[72:75], v[112:115], v[60:63]
    ds_read_b128 v[108:111], v5 offset:36864
    v_mfma_f32_16x16x32_bf16 v[64:67], v[76:79], v[112:115], v[64:67]
    v_mfma_f32_16x16x32_bf16 v[68:71], v[80:83], v[112:115], v[68:71]
    s_waitcnt lgkmcnt(2)
    s_barrier
    s_cbranch_scc1 L_tail
    s_nop 0
L_a7:
    v_mfma_f32_16x16x32_bf16 v[12:15], v[84:87], v[96:99], v[12:15]
    v_mfma_f32_16x16x32_bf16 v[16:19], v[88:91], v[96:99], v[16:19]
    v_mfma_f32_16x16x32_bf16 v[20:23], v[92:95], v[96:99], v[20:23]
    v_mfma_f32_16x16x32_bf16 v[32:35], v[92:95], v[100:103], v[32:35]
    ds_read_b128 v[112:115], v5 offset:38912
    v_mfma_f32_16x16x32_bf16 v[28:31], v[88:91], v[100:103], v[28:31]
    ds_read_b64_tr_b16 v[72:73], v1 offset:36864
    ds_read_b64_tr_b16 v[74:75], v1 offset:37376
    v_mfma_f32_16x16x32_bf16 v[24:27], v[84:87], v[100:103], v[24:27]
    ds_read_b128 v[96:99], v4 offset:40960
    s_waitcnt lgkmcnt(5)
    s_nop 0
    v_mfma_f32_16x16x32_bf16 v[36:39], v[84:87], v[104:107], v[36:39]
    ds_read_b64_tr_b16 v[76:77], v2 offset:36864
    ds_read_b64_tr_b16 v[78:79], v2 offset:37376
    v_mfma_f32_16x16x32_bf16 v[40:43], v[88:91], v[104:107], v[40:43]
    ds_read_b128 v[100:103], v4 offset:43008
    v_mfma_f32_16x16x32_bf16 v[44:47], v[92:95], v[104:107], v[44:47]
    s_waitcnt lgkmcnt(7)
    s_nop 0
    ds_read_b64_tr_b16 v[80:81], v3 offset:36864
    v_mfma_f32_16x16x32_bf16 v[56:59], v[92:95], v[108:111], v[56:59]
    ds_read_b64_tr_b16 v[82:83], v3 offset:37376
    ds_read_b128 v[104:107], v4 offset:45056
    v_mfma_f32_16x16x32_bf16 v[52:55], v[88:91], v[108:111], v[52:55]
    v_mfma_f32_16x16x32_bf16 v[48:51], v[84:87], v[108:111], v[48:51]
    s_waitcnt lgkmcnt(9)
    s_nop 0
    v_mfma_f32_16x16x32_bf16 v[60:63], v[84:87], v[112:115], v[60:63]
    ds_read_b128 v[108:111], v4 offset:47104
    v_mfma_f32_16x16x32_bf16 v[64:67], v[88:91], v[112:115], v[64:67]
    v_mfma_f32_16x16x32_bf16 v[68:71], v[92:95], v[112:115], v[68:71]
    s_waitcnt lgkmcnt(2)
    s_barrier
L_a8:
    v_mfma_f32_16x16x32_bf16 v[12:15], v[72:75], v[96:99], v[12:15]
    v_mfma_f32_16x16x32_bf16 v[16:19], v[76:79], v[96:99], v[16:19]
    v_mfma_f32_16x16x32_bf16 v[20:23], v[80:83], v[96:99], v[20:23]
    v_mfma_f32_16x16x32_bf16 v[32:35], v[80:83], v[100:103], v[32:35]
    ds_read_b128 v[112:115], v4 offset:49152
    v_mfma_f32_16x16x32_bf16 v[28:31], v[76:79], v[100:103], v[28:31]
    ds_read_b64_tr_b16 v[84:85], v1 offset:49152
    ds_read_b64_tr_b16 v[86:87], v1 offset:49664
    v_mfma_f32_16x16x32_bf16 v[24:27], v[72:75], v[100:103], v[24:27]
    ds_read_b128 v[96:99], v5 offset:40960
    s_waitcnt lgkmcnt(5)
    s_nop 0
    v_mfma_f32_16x16x32_bf16 v[36:39], v[72:75], v[104:107], v[36:39]
    ds_read_b64_tr_b16 v[88:89], v2 offset:49152
    ds_read_b64_tr_b16 v[90:91], v2 offset:49664
    v_mfma_f32_16x16x32_bf16 v[40:43], v[76:79], v[104:107], v[40:43]
    ds_read_b128 v[100:103], v5 offset:43008
    v_mfma_f32_16x16x32_bf16 v[44:47], v[80:83], v[104:107], v[44:47]
    s_waitcnt lgkmcnt(7)
    s_nop 0
    ds_read_b64_tr_b16 v[92:93], v3 offset:49152
    v_mfma_f32_16x16x32_bf16 v[56:59], v[80:83], v[108:111], v[56:59]
    ds_read_b64_tr_b16 v[94:95], v3 offset:49664
    ds_read_b128 v[104:107], v5 offset:45056
    v_mfma_f32_16x16x32_bf16 v[52:55], v[76:79], v[108:111], v[52:55]
    s_sub_u32 s71, s71, 1
    s_cmp_eq_u32 s71, 0
    v_mfma_f32_16x16x32_bf16 v[48:51], v[72:75], v[108:111], v[48:51]
    s_waitcnt lgkmcnt(9)
    s_nop 0
    v_mfma_f32_16x16x32_bf16 v[60:63], v[72:75], v[112:115], v[60:63]
    ds_read_b128 v[108:111], v5 offset:47104
    v_mfma_f32_16x16x32_bf16 v[64:67], v[76:79], v[112:115], v[64:67]
    v_mfma_f32_16x16x32_bf16 v[68:71], v[80:83], v[112:115], v[68:71]
    s_waitcnt lgkmcnt(2)
    s_barrier
    s_cbranch_scc1 L_tail
    s_nop 0
L_a9:
    v_mfma_f32_16x16x32_bf16 v[12:15], v[84:87], v[96:99], v[12:15]
    v_mfma_f32_16x16x32_bf16 v[16:19], v[88:91], v[96:99], v[16:19]
    v_mfma_f32_16x16x32_bf16 v[20:23], v[92:95], v[96:99], v[20:23]
    v_mfma_f32_16x16x32_bf16 v[32:35], v[92:95], v[100:103], v[32:35]
    ds_read_b128 v[112:115], v5 offset:49152
    v_mfma_f32_16x16x32_bf16 v[28:31], v[88:91], v[100:103], v[28:31]
    ds_read_b64_tr_b16 v[72:73], v1 offset:0
    ds_read_b64_tr_b16 v[74:75], v1 offset:512
    v_mfma_f32_16x16x32_bf16 v[24:27], v[84:87], v[100:103], v[24:27]
    ds_read_b128 v[96:99], v4 offset:51200
    s_waitcnt lgkmcnt(5)
    s_nop 0
    v_mfma_f32_16x16x32_bf16 v[36:39], v[84:87], v[104:107], v[36:39]
    ds_read_b64_tr_b16 v[76:77], v2 offset:0
    ds_read_b64_tr_b16 v[78:79], v2 offset:512
    v_mfma_f32_16x16x32_bf16 v[40:43], v[88:91], v[104:107], v[40:43]
    ds_read_b128 v[100:103], v4 offset:53248
    v_mfma_f32_16x16x32_bf16 v[44:47], v[92:95], v[104:107], v[44:47]
    s_waitcnt lgkmcnt(7)
    s_nop 0
    ds_read_b64_tr_b16 v[80:81], v3 offset:0
    v_mfma_f32_16x16x32_bf16 v[56:59], v[92:95], v[108:111], v[56:59]
    ds_read_b64_tr_b16 v[82:83], v3 offset:512
    ds_read_b128 v[104:107], v4 offset:55296
    v_mfma_f32_16x16x32_bf16 v[52:55], v[88:91], v[108:111], v[52:55]
    v_add_u32 v5, 51200, v5
    v_mfma_f32_16x16x32_bf16 v[48:51], v[84:87], v[108:111], v[48:51]
    s_waitcnt lgkmcnt(9)
    s_nop 0
    v_mfma_f32_16x16x32_bf16 v[60:63], v[84:87], v[112:115], v[60:63]
    ds_read_b128 v[108:111], v4 offset:57344
    v_mfma_f32_16x16x32_bf16 v[64:67], v[88:91], v[112:115], v[64:67]
    v_add_u32 v4, 51200, v4
    v_mfma_f32_16x16x32_bf16 v[68:71], v[92:95], v[112:115], v[68:71]
    s_waitcnt lgkmcnt(2)
    s_barrier
    s_branch L_a0
.p2align 3
L_tail:
    s_cmp_eq_u32 s69, 5
    s_cbranch_scc1 L_ret5
    v_mfma_f32_16x16x32_bf16 v[12:15], v[84:87], v[96:99], v[12:15]
    ds_read_b128 v[112:115], v11
    v_mfma_f32_16x16x32_bf16 v[16:19], v[88:91], v[96:99], v[16:19]
    v_mfma_f32_16x16x32_bf16 v[20:23], v[92:95], v[96:99], v[20:23]
    v_mfma_f32_16x16x32_bf16 v[32:35], v[92:95], v[100:103], v[32:35]
    v_mfma_f32_16x16x32_bf16 v[28:31], v[88:91], v[100:103], v[28:31]
    v_mfma_f32_16x16x32_bf16 v[24:27], v[84:87], v[100:103], v[24:27]
    s_waitcnt lgkmcnt(2)
    s_nop 0
    v_mfma_f32_16x16x32_bf16 v[36:39], v[84:87], v[104:107], v[36:39]
    v_mfma_f32_16x16x32_bf16 v[40:43], v[88:91], v[104:107], v[40:43]
    v_mfma_f32_16x16x32_bf16 v[44:47], v[92:95], v[104:107], v[44:47]
    s_waitcnt lgkmcnt(0)
    s_nop 0
    v_mfma_f32_16x16x32_bf16 v[56:59], v[92:95], v[108:111], v[56:59]
    v_mfma_f32_16x16x32_bf16 v[52:55], v[88:91], v[108:111], v[52:55]
    v_mfma_f32_16x16x32_bf16 v[48:51], v[84:87], v[108:111], v[48:51]
    v_mfma_f32_16x16x32_bf16 v[60:63], v[84:87], v[112:115], v[60:63]
    v_mfma_f32_16x16x32_bf16 v[64:67], v[88:91], v[112:115], v[64:67]
    v_mfma_f32_16x16x32_bf16 v[68:71], v[92:95], v[112:115], v[68:71]
    s_barrier
    s_setprio 0
    s_cmp_eq_u32 s69, 0
    s_cbranch_scc1 L_ret0
    s_cmp_eq_u32 s69, 1
    s_cbranch_scc1 L_ret1
    s_cmp_eq_u32 s69, 2
    s_cbranch_scc1 L_ret2
    s_cmp_eq_u32 s69, 3
    s_cbranch_scc1 L_ret3
    s_cmp_eq_u32 s69, 4
    s_cbranch_scc1 L_ret4
    s_branch L_ret5
L_loader:
    s_setprio 3
    v_lshrrev_b32 v13, 3, v0
    s_lshl_b32 s8, s4, 3
    v_add_u32 v13, s8, v13
    v_bfe_u32 v2, v13, 1, 1
    v_bfe_u32 v3, v13, 3, 1
    v_lshl_or_b32 v2, v3, 1, v2
    v_bfe_u32 v3, v0, 1, 2
    v_xor_b32 v2, v2, v3
    v_and_b32 v3, 1, v0
    v_lshlrev_b32 v3, 4, v3
    v_lshl_add_u32 v4, v2, 5, v3
    v_mul_u32_u24 v3, 9216, v13
    v_add_u32 v150, v3, v4
    v_mul_u32_u24 v3, 1152, v13
    v_add_u32 v151, v3, v4
    v_add_u32 v140, 2048, v150
    v_add_u32 v141, 1152, v150
    v_add_u32 v142, 256, v150
    s_mul_i32 s70, s4, 3072
    s_add_u32 s71, s70, 61440
    s_mov_b32 m0, s70
    s_mul_i32 s69, s47, 1152
    s_mul_i32 s68, s76, 589824
    s_add_u32 s69, s69, 384
    s_add_u32 s68, s68, s69
    s_add_u32 s69, s69, 5308416
    s_mov_b32 s67, s68
    s_mov_b32 s54, 5310464
    s_mov_b32 s55, 0x20000
    s_waitcnt lgkmcnt(0)
    s_sub_u32 s52, s36, 2048
    s_subb_u32 s53, s37, 0
    s_and_b32 s53, s53, 0xffff
    buffer_load_dwordx4 v140, s[52:55], s68 offen offset:0 lds
    buffer_load_dwordx4 v141, s[52:55], s68 offen offset:1024 lds
    buffer_load_dwordx4 v142, s[52:55], s68 offen offset:2048 lds
    s_add_u32 m0, m0, 12288
    s_cmp_eq_u32 m0, s71
    s_cselect_b32 m0, s70, m0
    s_add_u32 s68, s68, 294912
    s_barrier
    buffer_load_dwordx4 v140, s[52:55], s68 offen offset:0 lds
    buffer_load_dwordx4 v141, s[52:55], s68 offen offset:1024 lds
    buffer_load_dwordx4 v142, s[52:55], s68 offen offset:2048 lds
    s_add_u32 m0, m0, 12288
    s_cmp_eq_u32 m0, s71
    s_cselect_b32 m0, s70, m0
    s_add_u32 s68, s68, 294912
    s_cmp_eq_u32 s68, s69
    s_cselect_b32 s8, 5308416, 0
    s_cselect_b32 s69, s67, s69
    s_sub_u32 s68, s68, s8
    buffer_load_dwordx4 v140, s[52:55], s68 offen offset:0 lds
    buffer_load_dwordx4 v141, s[52:55], s68 offen offset:1024 lds
    buffer_load_dwordx4 v142, s[52:55], s68 offen offset:2048 lds
    s_add_u32 m0, m0, 12288
    s_cmp_eq_u32 m0, s71
    s_cselect_b32 m0, s70, m0
    s_add_u32 s68, s68, 294912
    buffer_load_dwordx4 v140, s[52:55], s68 offen offset:0 lds
    buffer_load_dwordx4 v141, s[52:55], s68 offen offset:1024 lds
    buffer_load_dwordx4 v142, s[52:55], s68 offen offset:2048 lds
    s_add_u32 m0, m0, 12288
    s_cmp_eq_u32 m0, s71
    s_cselect_b32 m0, s70, m0
    s_add_u32 s68, s68, 294912
    s_cmp_eq_u32 s68, s69
    s_cselect_b32 s8, 5308416, 0
    s_cselect_b32 s69, s67, s69
    s_sub_u32 s68, s68, s8
    v_add_u32 v143, 2048, v151
    v_add_u32 v144, 1152, v151
    v_add_u32 v145, 256, v151
    s_mov_b32 s64, 0x3f803f80
    s_mov_b32 s65, 0x00003f80
    s_mov_b32 s66, 0x3f800000
    s_sub_u32 s56, s38, 2048
    s_subb_u32 s57, s39, 0
    s_and_b32 s57, s57, 0xffff
    s_mov_b32 s58, 5310464
    s_mov_b32 s59, 0x20000
    s_mov_b32 s60, s44
    s_and_b32 s61, s45, 0xffff
    s_mov_b32 s62, 268435456
    s_mov_b32 s63, 0x20000
    s_waitcnt vmcnt(9)
    s_barrier
    buffer_load_dwordx4 v140, s[52:55], s68 offen offset:0 lds
    buffer_load_dwordx4 v141, s[52:55], s68 offen offset:1024 lds
    buffer_load_dwordx4 v142, s[52:55], s68 offen offset:2048 lds
    s_add_u32 m0, m0, 12288
    s_cmp_eq_u32 m0, s71
    s_cselect_b32 m0, s70, m0
    s_add_u32 s68, s68, 294912
    s_waitcnt vmcnt(9)
.p2align 3
    s_nop 0
L_ld_3:
    s_barrier
    buffer_load_dwordx4 v140, s[52:55], s68 offen offset:0 lds
    buffer_load_dwordx4 v141, s[52:55], s68 offen offset:1024 lds
    buffer_load_dwordx4 v142, s[52:55], s68 offen offset:2048 lds
    s_add_u32 m0, m0, 12288
    s_cmp_eq_u32 m0, s71
    s_cselect_b32 m0, s70, m0
    s_add_u32 s68, s68, 294912
    s_cmp_lg_u32 s68, s69
    s_waitcnt vmcnt(9)
    s_cbranch_scc1 L_ld_3
    s_cmp_eq_u32 s68, s67
    s_cselect_b32 s8, 0, 5308416
    s_sub_u32 s68, s68, s8
    s_mov_b32 s69, s67
    s_cmp_lg_u32 s68, s69
    s_cbranch_scc1 L_ld_3
    s_mul_i32 s69, s47, 1152
    s_mul_i32 s68, s76, 589824
    s_add_u32 s69, s69, 0
    s_add_u32 s68, s68, s69
    s_add_u32 s69, s69, 5308416
    s_mov_b32 s67, s68
    v_lshrrev_b32 v6, 5, v0
    v_and_b32 v7, 7, v0
    v_xor_b32 v6, v6, v7
    v_lshlrev_b32 v6, 4, v6
    v_and_b32 v7, 15, v0
    v_lshl_add_u32 v6, v7, 7, v6
    v_bfe_u32 v7, v0, 4, 1
    v_lshl_add_u32 v6, v7, 3, v6
    s_sub_u32 s8, s47, 5
    s_lshl_b32 s8, s8, 1
    s_add_u32 s9, s4, 12
    s_cmp_lt_u32 s47, 5
    s_cselect_b32 s8, s47, s8
    s_cselect_b32 s10, s4, 8
    s_cselect_b32 s11, 1, 0
    s_add_u32 s9, s9, s10
    s_lshr_b32 s10, s9, 2
    s_sub_u32 s10, s10, s101
    s_cselect_b32 s100, 9, 0
    s_add_u32 s10, s10, s100
    s_mul_i32 s10, s10, 5
    s_add_u32 s10, s10, s8
    s_lshl_b32 s10, s10, 11
    s_and_b32 s100, s9, 3
    s_lshl_b32 s100, s100, 5
    s_or_b32 s10, s10, s100
    v_xor_b32 v152, s10, v6
    s_add_u32 s9, s9, s11
    s_xor_b32 s11, s11, 1
    s_add_u32 s8, s8, s11
    s_lshr_b32 s10, s9, 2
    s_sub_u32 s10, s10, s101
    s_cselect_b32 s100, 9, 0
    s_add_u32 s10, s10, s100
    s_mul_i32 s10, s10, 5
    s_add_u32 s10, s10, s8
    s_lshl_b32 s10, s10, 11
    s_and_b32 s100, s9, 3
    s_lshl_b32 s100, s100, 5
    s_or_b32 s10, s10, s100
    v_xor_b32 v162, s10, v6
.p2align 3
    s_nop 0
L_ld_4:
    s_barrier
    buffer_load_dwordx4 v140, s[52:55], s68 offen offset:0 lds
    buffer_load_dwordx4 v141, s[52:55], s68 offen offset:1024 lds
    buffer_load_dwordx4 v142, s[52:55], s68 offen offset:2048 lds
    s_add_u32 m0, m0, 12288
    s_cmp_eq_u32 m0, s71
    s_cselect_b32 m0, s70, m0
    s_add_u32 s68, s68, 294912
    s_cmp_lg_u32 s68, s69
    s_waitcnt vmcnt(9)
    s_cbranch_scc1 L_ld_4
    s_cmp_eq_u32 s68, s67
    s_cselect_b32 s8, 0, 5308416
    s_sub_u32 s68, s68, s8
    s_mov_b32 s69, s67
    s_cmp_lg_u32 s68, s69
    s_cbranch_scc1 L_ld_4
    s_mul_i32 s69, s47, 1152
    s_mul_i32 s68, s76, 589824
    s_add_u32 s69, s69, 768
    s_add_u32 s68, s68, s69
    s_add_u32 s69, s69, 5308416
    s_mov_b32 s67, s68
    ds_read_b64 v[152:153], v152 offset:61440
    ds_read_b64 v[162:163], v162 offset:61440
.p2align 3
    s_nop 0
L_ld_5:
    s_barrier
    buffer_load_dwordx4 v140, s[52:55], s68 offen offset:0 lds
    buffer_load_dwordx4 v141, s[52:55], s68 offen offset:1024 lds
    buffer_load_dwordx4 v142, s[52:55], s68 offen offset:2048 lds
    s_add_u32 m0, m0, 12288
    s_cmp_eq_u32 m0, s71
    s_cselect_b32 m0, s70, m0
    s_add_u32 s68, s68, 294912
    s_cmp_lg_u32 s68, s69
    s_waitcnt vmcnt(9) lgkmcnt(0)
    s_cbranch_scc1 L_ld_5
    s_cmp_eq_u32 s68, s67
    s_cselect_b32 s8, 0, 5308416
    s_sub_u32 s68, s68, s8
    s_mov_b32 s69, s67
    s_cmp_lg_u32 s68, s69
    s_cbranch_scc1 L_ld_5
    s_mul_i32 s68, s47, 663552
    s_add_u32 s68, s68, 0
    s_add_u32 s69, s68, 663552
.p2align 3
    s_nop 0
L_ld_6:
    s_barrier
    buffer_load_dwordx4 v143, s[56:59], s68 offen offset:0 lds
    buffer_load_dwordx4 v144, s[56:59], s68 offen offset:1024 lds
    buffer_load_dwordx4 v145, s[56:59], s68 offen offset:2048 lds
    s_add_u32 m0, m0, 12288
    s_cmp_eq_u32 m0, s71
    s_cselect_b32 m0, s70, m0
    s_add_u32 s68, s68, 36864
    s_cmp_lg_u32 s68, s69
    s_waitcnt vmcnt(9)
    s_cbranch_scc1 L_ld_6
    s_mul_i32 s68, s47, 663552
    s_add_u32 s68, s68, 384
    s_add_u32 s69, s68, 663552
.p2align 3
    s_nop 0
L_ld_7:
    s_barrier
    buffer_load_dwordx4 v143, s[56:59], s68 offen offset:0 lds
    buffer_load_dwordx4 v144, s[56:59], s68 offen offset:1024 lds
    buffer_load_dwordx4 v145, s[56:59], s68 offen offset:2048 lds
    s_add_u32 m0, m0, 12288
    s_cmp_eq_u32 m0, s71
    s_cselect_b32 m0, s70, m0
    s_add_u32 s68, s68, 36864
    s_cmp_lg_u32 s68, s69
    s_waitcnt vmcnt(9)
    s_cbranch_scc1 L_ld_7
    s_mul_i32 s68, s47, 663552
    s_add_u32 s68, s68, 768
    s_add_u32 s69, s68, 663552
.p2align 3
    s_nop 0
L_ld_8:
    s_barrier
    buffer_load_dwordx4 v143, s[56:59], s68 offen offset:0 lds
    buffer_load_dwordx4 v144, s[56:59], s68 offen offset:1024 lds
    buffer_load_dwordx4 v145, s[56:59], s68 offen offset:2048 lds
    s_add_u32 m0, m0, 12288
    s_cmp_eq_u32 m0, s71
    s_cselect_b32 m0, s70, m0
    s_add_u32 s68, s68, 36864
    s_cmp_lg_u32 s68, s69
    s_waitcnt vmcnt(9)
    s_cbranch_scc1 L_ld_8
    s_barrier
    s_waitcnt vmcnt(6)
    s_barrier
    s_waitcnt vmcnt(3)
    s_barrier
    s_waitcnt vmcnt(0)
    s_barrier
    s_waitcnt lgkmcnt(0)
    s_lshl_b32 s79, s3, 10
    s_add_u32 s79, s79, 36864
    s_mul_i32 s74, s46, 12
    s_mov_b32 s78, 4
    s_add_u32 s74, s74, s4
    s_add_u32 s74, s74, 4
    s_mov_b32 s75, s47
    s_mov_b32 s25, 157696
    s_mov_b32 s77, 0
L_red1:
    s_setprio 0
    s_mul_i32 s7, s74, 128
    s_add_u32 s7, s7, 29360128
    v_cmp_gt_u32 vcc, 8, v0
    v_mov_b32 v161, s78
    v_xor_b32 v7, s47, v0
    v_cndmask_b32 v7, v0, v7, vcc
    v_lshlrev_b32 v7, 2, v7
    s_mov_b64 exec, 0xfffff
    buffer_load_dword v160, v7, s[60:63], s7 offen sc0 sc1
    s_mov_b64 exec, -1
    v_cndmask_b32 v161, 1, v161, vcc
    s_lshl_b32 s8, s4, 10
    s_add_u32 s8, s8, s25
    v_lshl_add_u32 v76, v0, 4, s8
    s_mul_i32 s27, s74, 0x1556
    s_lshr_b32 s27, s27, 16
    s_mul_i32 s28, s27, 12
    s_sub_u32 s28, s74, s28
    s_mul_i32 s27, s27, 79
    s_and_b32 s29, s28, 3
    s_lshr_b32 s28, s28, 2
    s_mul_i32 s28, s28, 12
    s_add_u32 s28, s28, s29
    s_lshl_b32 s28, s28, 2
    s_lshl_b32 s29, s29, 2
    s_mul_i32 s10, s74, 65536
    v_and_b32 v2, 15, v0
    v_lshrrev_b32 v3, 4, v0
    s_bfe_u32 s6, s75, 196608
    s_mul_i32 s12, s6, 8192
    s_cmp_eq_u32 s6, 7
    s_cselect_b32 s11, 504, 0
    v_lshrrev_b32 v4, 5, v0
    v_mul_u32_u24 v4, s11, v4
    v_lshlrev_b32 v74, 4, v0
    v_sub_u32 v74, v74, v4
    s_cselect_b32 s11, 496, -1
    v_min_u32 v74, s11, v74
    v_add_u32 v74, s12, v74
    s_sub_u32 s12, s6, 5
    s_lshl_b32 s12, s12, 1
    s_cmp_lt_u32 s6, 5
    s_cselect_b32 s13, s6, s12
    s_cselect_b32 s14, 0, 128
    s_cselect_b32 s15, s29, 32
    s_cselect_b32 s18, 65536, 0
    s_cselect_b32 s19, 2, 1
    s_cselect_b32 s20, 3, 1
    s_cselect_b32 s26, 32, 512
    s_lshl_b32 s13, s13, 4
    s_add_u32 s9, s28, s15
    v_lshrrev_b32 v4, s19, v0
    v_add_u32 v4, s13, v4
    v_and_b32 v5, s20, v0
    v_add_u32 v6, s27, v4
    v_mul_u32_u24 v44, 1152, v6
    s_lshl_b32 s12, s9, 3
    v_lshl_add_u32 v5, v5, 4, s12
    v_add_u32 v44, v44, v5
    v_cmp_lt_u32 vcc, 78, v4
    v_mov_b32 v6, 0x8000000
    s_add_u32 s12, s79, 0
    v_lshl_add_u32 v45, v0, 4, s12
    v_cndmask_b32 v44, v44, v6, vcc
    s_add_u32 s19, s19, 4
    v_lshlrev_b32 v4, s19, v2
    v_lshl_add_u32 v4, v3, 3, v4
    v_add_u32 v72, s12, v4
    v_add_u32 v73, s26, v72
    s_add_u32 s8, s27, s13
    v_add_lshl_u32 v60, v2, s8, 3
    v_add_u32 v61, s14, v60
    v_min_u32 v60, 16376, v60
    v_min_u32 v61, 16376, v61
    v_add_lshl_u32 v5, v3, s9, 14
    v_add_u32 v62, v5, v60
    v_add3_u32 v63, v5, v61, s18
    s_mov_b32 s21, 20971520
    s_mov_b32 s22, 25165824
    s_mov_b32 s23, 0
L_red1_mid:
    s_waitcnt vmcnt(0)
L_red1_mid2:
L_red1_poll:
    v_cmp_le_u32 vcc, v161, v160
    s_andn2_b32 s12, 0xfff00, vcc_lo
    s_cselect_b32 s12, 0, 0x100
    s_and_b32 s24, vcc_lo, 0xff
    s_or_b32 s24, s24, s12
    s_andn2_b32 s24, s24, s23
    s_cbranch_scc1 L_red1_ld
    s_sleep 1
L_red1_ld:
    s_mov_b32 s12, s10
    s_bitcmp1_b32 s24, 0
    s_cbranch_scc0 L_red1_l0
    ds_read_b128 v[8:11], v76
L_red1_l0:
    s_add_u32 s12, s12, 1024
    s_bitcmp1_b32 s24, 1
    s_cbranch_scc0 L_red1_l1
    buffer_load_dwordx4 v[12:15], v74, s[60:63], s12 offen sc0 sc1
L_red1_l1:
    s_add_u32 s12, s12, 1024
    s_bitcmp1_b32 s24, 2
    s_cbranch_scc0 L_red1_l2
    buffer_load_dwordx4 v[16:19], v74, s[60:63], s12 offen sc0 sc1
L_red1_l2:
    s_add_u32 s12, s12, 1024
    s_bitcmp1_b32 s24, 3
    s_cbranch_scc0 L_red1_l3
    buffer_load_dwordx4 v[20:23], v74, s[60:63], s12 offen sc0 sc1
L_red1_l3:
    s_add_u32 s12, s12, 1024
    s_bitcmp1_b32 s24, 4
    s_cbranch_scc0 L_red1_l4
    buffer_load_dwordx4 v[24:27], v74, s[60:63], s12 offen sc0 sc1
L_red1_l4:
    s_add_u32 s12, s12, 1024
    s_bitcmp1_b32 s24, 5
    s_cbranch_scc0 L_red1_l5
    buffer_load_dwordx4 v[28:31], v74, s[60:63], s12 offen sc0 sc1
L_red1_l5:
    s_add_u32 s12, s12, 1024
    s_bitcmp1_b32 s24, 6
    s_cbranch_scc0 L_red1_l6
    buffer_load_dwordx4 v[32:35], v74, s[60:63], s12 offen sc0 sc1
L_red1_l6:
    s_add_u32 s12, s12, 1024
    s_bitcmp1_b32 s24, 7
    s_cbranch_scc0 L_red1_l7
    buffer_load_dwordx4 v[36:39], v74, s[60:63], s12 offen sc0 sc1
L_red1_l7:
    s_bitcmp1_b32 s24, 8
    s_cbranch_scc0 L_red1_l8
    buffer_load_dword v46, v60, s[60:63], s22 offen sc0 sc1
    buffer_load_dwordx2 v[56:57], v62, s[60:63], s21 offen sc0 sc1
    buffer_load_dword v47, v61, s[60:63], s22 offen sc0 sc1
    buffer_load_dwordx2 v[58:59], v63, s[60:63], s21 offen sc0 sc1
L_red1_l8:
    s_or_b32 s23, s23, s24
    s_cmp_eq_u32 s23, 0x1ff
    s_cbranch_scc1 L_red1_go
    s_mov_b64 exec, 0xfffff
    buffer_load_dword v160, v7, s[60:63], s7 offen sc0 sc1
    s_mov_b64 exec, -1
    s_waitcnt vmcnt(0)
    s_branch L_red1_poll
L_red1_go:
    s_mov_b32 s56, s40
    s_and_b32 s57, s41, 0xffff
    s_mov_b32 s58, 2359296
    s_mov_b32 s59, 0x20000
    s_waitcnt lgkmcnt(0)
    v_lshlrev_b32 v64, 16, v152
    v_and_b32 v65, 0xffff0000, v152
    v_lshlrev_b32 v66, 16, v153
    v_and_b32 v67, 0xffff0000, v153
    v_lshlrev_b32 v68, 16, v162
    v_and_b32 v69, 0xffff0000, v162
    v_lshlrev_b32 v70, 16, v163
    v_and_b32 v71, 0xffff0000, v163
L_red1_go1:
    s_waitcnt vmcnt(0)
L_red1_go2:
    v_dot2_f32_bf16 v64, v56, s65, v64
    v_dot2_f32_bf16 v65, v56, s66, v65
    v_dot2_f32_bf16 v66, v57, s65, v66
    v_dot2_f32_bf16 v67, v57, s66, v67
    v_dot2_f32_bf16 v68, v58, s65, v68
    v_dot2_f32_bf16 v69, v58, s66, v69
    v_dot2_f32_bf16 v70, v59, s65, v70
    v_dot2_f32_bf16 v71, v59, s66, v71
    v_dot2_f32_bf16 v48, v8, s65, 0
    v_dot2_f32_bf16 v49, v8, s66, 0
    v_dot2_f32_bf16 v50, v9, s65, 0
    v_dot2_f32_bf16 v51, v9, s66, 0
    v_dot2_f32_bf16 v52, v10, s65, 0
    v_dot2_f32_bf16 v53, v10, s66, 0
    v_dot2_f32_bf16 v54, v11, s65, 0
    v_dot2_f32_bf16 v55, v11, s66, 0
    v_dot2_f32_bf16 v48, v12, s65, v48
    v_dot2_f32_bf16 v49, v12, s66, v49
    v_dot2_f32_bf16 v50, v13, s65, v50
    v_dot2_f32_bf16 v51, v13, s66, v51
    v_dot2_f32_bf16 v52, v14, s65, v52
    v_dot2_f32_bf16 v53, v14, s66, v53
    v_dot2_f32_bf16 v54, v15, s65, v54
    v_dot2_f32_bf16 v55, v15, s66, v55
    v_dot2_f32_bf16 v48, v16, s65, v48
    v_dot2_f32_bf16 v49, v16, s66, v49
    v_dot2_f32_bf16 v50, v17, s65, v50
    v_dot2_f32_bf16 v51, v17, s66, v51
    v_dot2_f32_bf16 v52, v18, s65, v52
    v_dot2_f32_bf16 v53, v18, s66, v53
    v_dot2_f32_bf16 v54, v19, s65, v54
    v_dot2_f32_bf16 v55, v19, s66, v55
    v_dot2_f32_bf16 v48, v20, s65, v48
    v_dot2_f32_bf16 v49, v20, s66, v49
    v_dot2_f32_bf16 v50, v21, s65, v50
    v_dot2_f32_bf16 v51, v21, s66, v51
    v_dot2_f32_bf16 v52, v22, s65, v52
    v_dot2_f32_bf16 v53, v22, s66, v53
    v_dot2_f32_bf16 v54, v23, s65, v54
    v_dot2_f32_bf16 v55, v23, s66, v55
    v_dot2_f32_bf16 v48, v24, s65, v48
    v_dot2_f32_bf16 v49, v24, s66, v49
    v_dot2_f32_bf16 v50, v25, s65, v50
    v_dot2_f32_bf16 v51, v25, s66, v51
    v_dot2_f32_bf16 v52, v26, s65, v52
    v_dot2_f32_bf16 v53, v26, s66, v53
    v_dot2_f32_bf16 v54, v27, s65, v54
    v_dot2_f32_bf16 v55, v27, s66, v55
    v_dot2_f32_bf16 v48, v28, s65, v48
    v_dot2_f32_bf16 v49, v28, s66, v49
    v_dot2_f32_bf16 v50, v29, s65, v50
    v_dot2_f32_bf16 v51, v29, s66, v51
    v_dot2_f32_bf16 v52, v30, s65, v52
    v_dot2_f32_bf16 v53, v30, s66, v53
    v_dot2_f32_bf16 v54, v31, s65, v54
    v_dot2_f32_bf16 v55, v31, s66, v55
    v_dot2_f32_bf16 v48, v32, s65, v48
    v_dot2_f32_bf16 v49, v32, s66, v49
    v_dot2_f32_bf16 v50, v33, s65, v50
    v_dot2_f32_bf16 v51, v33, s66, v51
    v_dot2_f32_bf16 v52, v34, s65, v52
    v_dot2_f32_bf16 v53, v34, s66, v53
    v_dot2_f32_bf16 v54, v35, s65, v54
    v_dot2_f32_bf16 v55, v35, s66, v55
    v_dot2_f32_bf16 v48, v36, s65, v48
    v_dot2_f32_bf16 v49, v36, s66, v49
    v_dot2_f32_bf16 v50, v37, s65, v50
    v_dot2_f32_bf16 v51, v37, s66, v51
    v_dot2_f32_bf16 v52, v38, s65, v52
    v_dot2_f32_bf16 v53, v38, s66, v53
    v_dot2_f32_bf16 v54, v39, s65, v54
    v_dot2_f32_bf16 v55, v39, s66, v55
    v_cvt_pk_bf16_f32 v40, v64, v65
    v_cvt_pk_bf16_f32 v41, v66, v67
    v_cvt_pk_bf16_f32 v42, v68, v69
    v_cvt_pk_bf16_f32 v43, v70, v71
    v_mul_f32 v48, v46, v48
    v_mul_f32 v49, v46, v49
    v_mul_f32 v50, v46, v50
    v_mul_f32 v51, v46, v51
    v_mul_f32 v52, v47, v52
    v_mul_f32 v53, v47, v53
    v_mul_f32 v54, v47, v54
    v_mul_f32 v55, v47, v55
    v_lshlrev_b32 v64, 16, v40
    v_and_b32 v65, 0xffff0000, v40
    v_lshlrev_b32 v66, 16, v41
    v_and_b32 v67, 0xffff0000, v41
    v_lshlrev_b32 v68, 16, v42
    v_and_b32 v69, 0xffff0000, v42
    v_lshlrev_b32 v70, 16, v43
    v_and_b32 v71, 0xffff0000, v43
    v_cvt_pk_bf16_f32 v8, v48, v49
    v_cvt_pk_bf16_f32 v9, v50, v51
    v_cvt_pk_bf16_f32 v10, v52, v53
    v_cvt_pk_bf16_f32 v11, v54, v55
    v_dot2_f32_bf16 v64, v8, s65, v64
    v_dot2_f32_bf16 v65, v8, s66, v65
    v_dot2_f32_bf16 v66, v9, s65, v66
    v_dot2_f32_bf16 v67, v9, s66, v67
    v_dot2_f32_bf16 v68, v10, s65, v68
    v_dot2_f32_bf16 v69, v10, s66, v69
    v_dot2_f32_bf16 v70, v11, s65, v70
    v_dot2_f32_bf16 v71, v11, s66, v71
    s_nop 0
    v_cvt_pk_bf16_f32 v8, v64, v65
    v_cvt_pk_bf16_f32 v9, v66, v67
    ds_write_b64 v72, v[8:9]
    v_cvt_pk_bf16_f32 v10, v68, v69
    v_cvt_pk_bf16_f32 v11, v70, v71
    ds_write_b64 v73, v[10:11]
    ds_read_b128 v[12:15], v45
    s_waitcnt lgkmcnt(0)
    buffer_store_dwordx4 v[12:15], v44, s[56:59], 0 offen nt
    s_add_u32 s74, s74, 8
    s_mov_b32 s25, 49152
    s_cmp_lg_u32 s77, 0
    s_mov_b32 s77, 0
    s_cbranch_scc1 L_red1
    s_endpgm
L_ssm:
    s_cmp_lg_u32 s3, 7
    s_cbranch_scc1 L_nopf_9
    s_getpc_b64 s[6:7]
L_pc_10:
    s_sub_u32 s6, s6, L_pc_10-parallel_sum__ssm_conv_s4__dense_activation_relu__prompt_kernel
    s_subb_u32 s7, s7, 0
    s_lshr_b32 s10, s2, 3
    s_mul_i32 s11, s10, 52
    s_lshr_b32 s11, s11, 8
    s_mul_i32 s11, s11, 5
    s_sub_u32 s10, s10, s11
    s_lshl_b32 s10, s10, 13
    v_lshlrev_b32 v1, 7, v0
    v_add_u32 v1, s10, v1
    v_min_u32 v1, L_code_end-parallel_sum__ssm_conv_s4__dense_activation_relu__prompt_kernel, v1
    global_load_dword v167, v1, s[6:7]
L_nopf_9:
    s_mov_b32 s64, 0x3f803f80
    s_mov_b32 s65, 0x00003f80
    s_mov_b32 s66, 0x3f800000
    s_mov_b32 s50, 2359296
    s_mov_b32 s51, 0x20000
    s_mov_b32 s62, 268435456
    s_mov_b32 s63, 0x20000
    s_setprio 2
    s_mul_i32 s10, s8, 6
    s_add_u32 s46, s10, s9
    s_mul_i32 s47, s3, 8512
    s_mov_b32 s76, s8
    s_mov_b32 s77, s9
    v_lshrrev_b32 v1, 4, v0
    v_and_b32 v2, 15, v0
    v_mul_u32_u24 v3, 1152, v1
    v_lshl_add_u32 v4, v2, 4, v3
    v_lshl_add_u32 v5, v2, 3, v3
    s_mul_i32 s12, s46, 55296
    s_mul_i32 s13, s3, 4608
    s_add_u32 s12, s12, s13
    s_waitcnt lgkmcnt(0)
    s_mov_b32 s48, s16
    s_and_b32 s49, s17, 0xffff
    s_mov_b32 s60, s44
    s_and_b32 s61, s45, 0xffff
    buffer_load_dwordx4 v[8:11], v4, s[48:51], s12 offen offset:0
    buffer_load_dwordx4 v[12:15], v4, s[48:51], s12 offen offset:256
    buffer_load_dwordx4 v[16:19], v4, s[48:51], s12 offen offset:512
    buffer_load_dwordx4 v[20:23], v4, s[48:51], s12 offen offset:768
    buffer_load_dwordx2 v[24:25], v5, s[48:51], s12 offen offset:1024
    s_mul_i32 s69, s5, 48
    s_add_u32 s69, s69, s46
    s_lshl_b32 s67, s69, 2
    s_add_u32 s67, s67, s4
    s_lshr_b32 s13, s67, 1
    s_lshl_b32 s13, s13, 2
    s_load_dword s14, s[30:31], s13
    s_load_dword s68, s[32:33], s13
    s_getpc_b64 s[6:7]
L_pc3:
    s_add_u32 s6, s6, L_xtab-L_pc3
    s_addc_u32 s7, s7, 0
    v_and_b32 v3, 7, v0
    v_lshlrev_b32 v3, 2, v3
    v_add_u32 v3, 163808, v3
    v_mov_b32 v4, 0
    ds_write_b32 v3, v4
    v_mul_u32_u24 v3, 1216, v1
    s_mul_i32 s13, s3, 4864
    s_lshr_b32 s15, s3, 1
    s_lshl_b32 s15, s15, 4
    s_add_u32 s13, s13, s15
    s_add_u32 s13, s13, 102144
    v_add_u32 v3, s13, v3
    v_lshl_add_u32 v140, v2, 4, v3
    v_lshl_add_u32 v141, v2, 3, v3
    v_bfe_u32 v3, v0, 2, 2
    v_mul_u32_u24 v3, 1216, v3
    s_mul_i32 s13, s3, 96
    s_add_u32 s13, s13, 102144
    v_add_u32 v3, s13, v3
    v_and_b32 v4, 3, v0
    v_mul_u32_u24 v5, 9744, v4
    v_lshl_add_u32 v5, v1, 3, v5
    v_add_u32 v142, v3, v5
    v_and_b32 v5, 1, v0
    v_mul_u32_u24 v5, 9744, v5
    v_lshl_add_u32 v5, v1, 4, v5
    v_lshlrev_b32 v4, 2, v4
    v_and_b32 v4, 8, v4
    v_add3_u32 v143, v3, v5, v4
    v_mul_u32_u24 v3, 16640, v1
    v_lshl_add_u32 v160, v2, 4, v3
    v_lshrrev_b32 v3, 3, v0
    v_mul_u32_u24 v3, 16640, v3
    v_and_b32 v4, 7, v0
    v_lshl_add_u32 v161, v4, 4, v3
    s_mov_b32 s52, s36
    s_and_b32 s53, s37, 0xffff
    s_mov_b32 s54, 5308416
    s_mov_b32 s55, 0x20000
    v_mul_u32_u24 v3, 43, v0
    v_lshrrev_b32 v3, 8, v3
    v_mul_u32_u24 v4, 6, v3
    v_sub_u32 v4, v0, v4
    v_cmp_lt_u32 vcc, 2, v4
    v_mul_u32_u24 v3, 9216, v3
    v_lshl_add_u32 v3, v4, 7, v3
    v_add_u32 v4, 768, v3
    v_cndmask_b32 v159, v3, v4, vcc
    s_lshr_b32 s13, s76, 1
    s_mul_i32 s71, s13, 2304
    s_lshl_b32 s13, s77, 2
    s_add_u32 s13, s13, s4
    s_mul_i32 s13, s13, 73728
    s_add_u32 s71, s71, s13
    s_waitcnt vmcnt(0)
    s_lshl_b32 s13, s67, 8
    v_lshl_add_u32 v6, v0, 2, s13
    global_load_dword v72, v6, s[18:19]
    global_load_dword v73, v6, s[20:21]
    global_load_dword v74, v6, s[22:23]
    global_load_dword v75, v6, s[24:25]
    global_load_dword v76, v6, s[26:27]
    global_load_dword v77, v6, s[28:29]
    v_lshlrev_b32 v6, 4, v0
    v_lshlrev_b32 v7, 3, v0
    global_load_dwordx4 v[78:81], v6, s[6:7]
    global_load_dwordx4 v[82:85], v6, s[6:7] offset:1024
    global_load_dwordx2 v[86:87], v7, s[6:7] offset:2048
    s_cmp_ge_u32 s46, 43
    s_cbranch_scc1 L_s_nopub
    v_dot2_f32_bf16 v64, v8, s64, 0
    v_dot2_f32_bf16 v65, v9, s64, 0
    v_dot2_f32_bf16 v64, v10, s64, v64
    v_dot2_f32_bf16 v65, v11, s64, v65
    v_dot2_f32_bf16 v64, v12, s64, v64
    v_dot2_f32_bf16 v65, v13, s64, v65
    v_dot2_f32_bf16 v64, v14, s64, v64
    v_dot2_f32_bf16 v65, v15, s64, v65
    v_dot2_f32_bf16 v64, v16, s64, v64
    v_dot2_f32_bf16 v65, v17, s64, v65
    v_dot2_f32_bf16 v64, v18, s64, v64
    v_dot2_f32_bf16 v65, v19, s64, v65
    v_dot2_f32_bf16 v64, v20, s64, v64
    v_dot2_f32_bf16 v65, v21, s64, v65
    v_dot2_f32_bf16 v64, v22, s64, v64
    v_dot2_f32_bf16 v65, v23, s64, v65
    v_dot2_f32_bf16 v64, v24, s64, v64
    v_dot2_f32_bf16 v65, v25, s64, v65
    s_nop 2
    v_add_f32 v64, v64, v65
    s_nop 1
    v_add_f32_dpp v64, v64, v64 row_ror:8 row_mask:0xf bank_mask:0xf
    s_nop 1
    v_add_f32_dpp v64, v64, v64 row_ror:4 row_mask:0xf bank_mask:0xf
    s_nop 1
    v_add_f32_dpp v64, v64, v64 row_ror:2 row_mask:0xf bank_mask:0xf
    s_nop 1
    v_add_f32_dpp v64, v64, v64 row_ror:1 row_mask:0xf bank_mask:0xf
    v_mul_f32 v66, 0x3ae38e39, v64
    v_cvt_pk_bf16_f32 v67, v66, v66
    v_lshlrev_b32 v67, 16, v67
    v_sub_f32 v66, v66, v67
    v_xor_b32 v67, 0x80000000, v67
    v_dot2_f32_bf16 v28, v8, s65, v67
    v_dot2_f32_bf16 v29, v8, s66, v67
    v_dot2_f32_bf16 v30, v9, s65, v67
    v_dot2_f32_bf16 v31, v9, s66, v67
    v_dot2_f32_bf16 v32, v10, s65, v67
    v_dot2_f32_bf16 v33, v10, s66, v67
    v_dot2_f32_bf16 v34, v11, s65, v67
    v_dot2_f32_bf16 v35, v11, s66, v67
    v_dot2_f32_bf16 v36, v12, s65, v67
    v_dot2_f32_bf16 v37, v12, s66, v67
    v_dot2_f32_bf16 v38, v13, s65, v67
    v_dot2_f32_bf16 v39, v13, s66, v67
    v_dot2_f32_bf16 v40, v14, s65, v67
    v_dot2_f32_bf16 v41, v14, s66, v67
    v_dot2_f32_bf16 v42, v15, s65, v67
    v_dot2_f32_bf16 v43, v15, s66, v67
    v_dot2_f32_bf16 v44, v16, s65, v67
    v_dot2_f32_bf16 v45, v16, s66, v67
    v_dot2_f32_bf16 v46, v17, s65, v67
    v_dot2_f32_bf16 v47, v17, s66, v67
    v_dot2_f32_bf16 v48, v18, s65, v67
    v_dot2_f32_bf16 v49, v18, s66, v67
    v_dot2_f32_bf16 v50, v19, s65, v67
    v_dot2_f32_bf16 v51, v19, s66, v67
    v_dot2_f32_bf16 v52, v20, s65, v67
    v_dot2_f32_bf16 v53, v20, s66, v67
    v_dot2_f32_bf16 v54, v21, s65, v67
    v_dot2_f32_bf16 v55, v21, s66, v67
    v_dot2_f32_bf16 v56, v22, s65, v67
    v_dot2_f32_bf16 v57, v22, s66, v67
    v_dot2_f32_bf16 v58, v23, s65, v67
    v_dot2_f32_bf16 v59, v23, s66, v67
    v_dot2_f32_bf16 v60, v24, s65, v67
    v_dot2_f32_bf16 v61, v24, s66, v67
    v_dot2_f32_bf16 v62, v25, s65, v67
    v_dot2_f32_bf16 v63, v25, s66, v67
    s_nop 0
    v_pk_mul_f32 v[68:69], v[28:29], v[28:29]
    v_pk_fma_f32 v[68:69], v[30:31], v[30:31], v[68:69]
    v_pk_fma_f32 v[68:69], v[32:33], v[32:33], v[68:69]
    v_pk_fma_f32 v[68:69], v[34:35], v[34:35], v[68:69]
    v_pk_fma_f32 v[68:69], v[36:37], v[36:37], v[68:69]
    v_pk_fma_f32 v[68:69], v[38:39], v[38:39], v[68:69]
    v_pk_fma_f32 v[68:69], v[40:41], v[40:41], v[68:69]
    v_pk_fma_f32 v[68:69], v[42:43], v[42:43], v[68:69]
    v_pk_fma_f32 v[68:69], v[44:45], v[44:45], v[68:69]
    v_pk_fma_f32 v[68:69], v[46:47], v[46:47], v[68:69]
    v_pk_fma_f32 v[68:69], v[48:49], v[48:49], v[68:69]
    v_pk_fma_f32 v[68:69], v[50:51], v[50:51], v[68:69]
    v_pk_fma_f32 v[68:69], v[52:53], v[52:53], v[68:69]
    v_pk_fma_f32 v[68:69], v[54:55], v[54:55], v[68:69]
    v_pk_fma_f32 v[68:69], v[56:57], v[56:57], v[68:69]
    v_pk_fma_f32 v[68:69], v[58:59], v[58:59], v[68:69]
    v_pk_fma_f32 v[68:69], v[60:61], v[60:61], v[68:69]
    v_pk_fma_f32 v[68:69], v[62:63], v[62:63], v[68:69]
    v_add_f32 v68, v68, v69
    v_cvt_pk_bf16_f32 v8, v28, v29
    v_cvt_pk_bf16_f32 v9, v30, v31
    v_add_f32_dpp v68, v68, v68 row_ror:8 row_mask:0xf bank_mask:0xf
    v_cvt_pk_bf16_f32 v10, v32, v33
    v_cvt_pk_bf16_f32 v11, v34, v35
    v_add_f32_dpp v68, v68, v68 row_ror:4 row_mask:0xf bank_mask:0xf
    v_cvt_pk_bf16_f32 v12, v36, v37
    v_cvt_pk_bf16_f32 v13, v38, v39
    v_add_f32_dpp v68, v68, v68 row_ror:2 row_mask:0xf bank_mask:0xf
    v_cvt_pk_bf16_f32 v14, v40, v41
    v_cvt_pk_bf16_f32 v15, v42, v43
    v_add_f32_dpp v68, v68, v68 row_ror:1 row_mask:0xf bank_mask:0xf
    v_mul_f32 v66, v66, v66
    v_mov_b32 v69, 0x3ae38e39
    v_fma_f32 v68, v68, v69, -v66
    v_max_f32 v68, 0, v68
    v_cvt_pk_bf16_f32 v68, v68, v68
    v_lshlrev_b32 v68, 16, v68
    v_add_f32 v68, 0x3727c5ac, v68
    v_cvt_pk_bf16_f32 v68, v68, v68
    v_lshlrev_b32 v68, 16, v68
    v_sqrt_f32 v68, v68
    v_cvt_pk_bf16_f32 v16, v44, v45
    v_cvt_pk_bf16_f32 v17, v46, v47
    v_cvt_pk_bf16_f32 v68, v68, v68
    v_lshlrev_b32 v68, 16, v68
    v_rcp_f32 v70, v68
    v_mov_b32 v71, v67
    v_cvt_pk_bf16_f32 v18, v48, v49
    v_cvt_pk_bf16_f32 v19, v50, v51
    v_cvt_pk_bf16_f32 v20, v52, v53
    v_cvt_pk_bf16_f32 v21, v54, v55
    v_cvt_pk_bf16_f32 v22, v56, v57
    v_cvt_pk_bf16_f32 v23, v58, v59
    v_cvt_pk_bf16_f32 v24, v60, v61
    v_cvt_pk_bf16_f32 v25, v62, v63
    v_lshlrev_b32 v28, 16, v8
    v_and_b32 v29, 0xffff0000, v8
    v_lshlrev_b32 v30, 16, v9
    v_and_b32 v31, 0xffff0000, v9
    v_lshlrev_b32 v32, 16, v10
    v_and_b32 v33, 0xffff0000, v10
    v_lshlrev_b32 v34, 16, v11
    v_and_b32 v35, 0xffff0000, v11
    v_lshlrev_b32 v36, 16, v12
    v_and_b32 v37, 0xffff0000, v12
    v_lshlrev_b32 v38, 16, v13
    v_and_b32 v39, 0xffff0000, v13
    v_lshlrev_b32 v40, 16, v14
    v_and_b32 v41, 0xffff0000, v14
    v_lshlrev_b32 v42, 16, v15
    v_and_b32 v43, 0xffff0000, v15
    v_lshlrev_b32 v44, 16, v16
    v_and_b32 v45, 0xffff0000, v16
    v_lshlrev_b32 v46, 16, v17
    v_and_b32 v47, 0xffff0000, v17
    v_lshlrev_b32 v48, 16, v18
    v_and_b32 v49, 0xffff0000, v18
    v_lshlrev_b32 v50, 16, v19
    v_and_b32 v51, 0xffff0000, v19
    v_lshlrev_b32 v52, 16, v20
    v_and_b32 v53, 0xffff0000, v20
    v_lshlrev_b32 v54, 16, v21
    v_and_b32 v55, 0xffff0000, v21
    v_lshlrev_b32 v56, 16, v22
    v_and_b32 v57, 0xffff0000, v22
    v_lshlrev_b32 v58, 16, v23
    v_and_b32 v59, 0xffff0000, v23
    v_lshlrev_b32 v60, 16, v24
    v_and_b32 v61, 0xffff0000, v24
    v_lshlrev_b32 v62, 16, v25
    v_and_b32 v63, 0xffff0000, v25
    v_pk_mul_f32 v[28:29], v[28:29], v[70:71] op_sel_hi:[1,0]
    v_pk_mul_f32 v[30:31], v[30:31], v[70:71] op_sel_hi:[1,0]
    v_pk_mul_f32 v[32:33], v[32:33], v[70:71] op_sel_hi:[1,0]
    v_pk_mul_f32 v[34:35], v[34:35], v[70:71] op_sel_hi:[1,0]
    v_pk_mul_f32 v[36:37], v[36:37], v[70:71] op_sel_hi:[1,0]
    v_pk_mul_f32 v[38:39], v[38:39], v[70:71] op_sel_hi:[1,0]
    v_pk_mul_f32 v[40:41], v[40:41], v[70:71] op_sel_hi:[1,0]
    v_pk_mul_f32 v[42:43], v[42:43], v[70:71] op_sel_hi:[1,0]
    v_pk_mul_f32 v[44:45], v[44:45], v[70:71] op_sel_hi:[1,0]
    v_pk_mul_f32 v[46:47], v[46:47], v[70:71] op_sel_hi:[1,0]
    v_pk_mul_f32 v[48:49], v[48:49], v[70:71] op_sel_hi:[1,0]
    v_pk_mul_f32 v[50:51], v[50:51], v[70:71] op_sel_hi:[1,0]
    v_pk_mul_f32 v[52:53], v[52:53], v[70:71] op_sel_hi:[1,0]
    v_pk_mul_f32 v[54:55], v[54:55], v[70:71] op_sel_hi:[1,0]
    v_pk_mul_f32 v[56:57], v[56:57], v[70:71] op_sel_hi:[1,0]
    v_pk_mul_f32 v[58:59], v[58:59], v[70:71] op_sel_hi:[1,0]
    v_pk_mul_f32 v[60:61], v[60:61], v[70:71] op_sel_hi:[1,0]
    v_pk_mul_f32 v[62:63], v[62:63], v[70:71] op_sel_hi:[1,0]
    v_cvt_pk_bf16_f32 v8, v28, v29
    v_cvt_pk_bf16_f32 v9, v30, v31
    v_cvt_pk_bf16_f32 v10, v32, v33
    v_cvt_pk_bf16_f32 v11, v34, v35
    ds_write_b128 v140, v[8:11] offset:0
    v_cvt_pk_bf16_f32 v12, v36, v37
    v_cvt_pk_bf16_f32 v13, v38, v39
    v_cvt_pk_bf16_f32 v14, v40, v41
    v_cvt_pk_bf16_f32 v15, v42, v43
    ds_write_b128 v140, v[12:15] offset:256
    v_cvt_pk_bf16_f32 v16, v44, v45
    v_cvt_pk_bf16_f32 v17, v46, v47
    v_cvt_pk_bf16_f32 v18, v48, v49
    v_cvt_pk_bf16_f32 v19, v50, v51
    ds_write_b128 v140, v[16:19] offset:512
    v_cvt_pk_bf16_f32 v20, v52, v53
    v_cvt_pk_bf16_f32 v21, v54, v55
    v_cvt_pk_bf16_f32 v22, v56, v57
    v_cvt_pk_bf16_f32 v23, v58, v59
    ds_write_b128 v140, v[20:23] offset:768
    v_cvt_pk_bf16_f32 v24, v60, v61
    v_cvt_pk_bf16_f32 v25, v62, v63
    ds_write_b64 v141, v[24:25] offset:1024
    s_mul_i32 s13, s46, 384
    s_lshl_b32 s15, s3, 5
    s_add_u32 s13, s13, s15
    s_add_u32 s13, s13, 25165824
    v_lshlrev_b32 v1, 3, v1
    s_mov_b32 exec_lo, 0x00010001
    s_mov_b32 exec_hi, 0x00010001
    buffer_store_dwordx2 v[70:71], v1, s[60:63], s13 offen sc0 sc1
    s_mov_b64 exec, -1
    s_mul_i32 s13, s46, 384
    s_mul_i32 s15, s3, 199680
    s_add_u32 s13, s13, s15
    s_add_u32 s13, s13, 26214400
    s_add_u32 s10, s13, 66560
    s_add_u32 s11, s13, 133120
    s_waitcnt lgkmcnt(0)
    s_barrier
    ds_read_b64_tr_b16 v[8:9], v142 offset:0
    ds_read_b64_tr_b16 v[10:11], v142 offset:4864
    ds_read_b64_tr_b16 v[12:13], v142 offset:32
    ds_read_b64_tr_b16 v[14:15], v142 offset:4896
    ds_read_b64_tr_b16 v[16:17], v142 offset:64
    ds_read_b64_tr_b16 v[18:19], v142 offset:4928
    ds_read_b64_tr_b16 v[20:21], v143 offset:38976
    ds_read_b64_tr_b16 v[22:23], v143 offset:43840
    ds_read_b64_tr_b16 v[24:25], v143 offset:39040
    ds_read_b64_tr_b16 v[26:27], v143 offset:43904
    s_waitcnt lgkmcnt(8)
    buffer_store_dwordx4 v[8:11], v160, s[60:63], s13 offen offset:0 sc0 sc1
    s_waitcnt lgkmcnt(6)
    buffer_store_dwordx4 v[12:15], v160, s[60:63], s10 offen offset:0 sc0 sc1
    s_waitcnt lgkmcnt(4)
    buffer_store_dwordx4 v[16:19], v160, s[60:63], s11 offen offset:0 sc0 sc1
    s_waitcnt lgkmcnt(2)
    buffer_store_dwordx4 v[20:23], v161, s[60:63], s13 offen offset:256 sc0 sc1
    s_waitcnt lgkmcnt(0)
    s_mov_b32 exec_hi, 0
    buffer_store_dwordx4 v[24:27], v161, s[60:63], s11 offen offset:256 sc0 sc1
    s_mov_b64 exec, -1
    s_waitcnt vmcnt(6)
    s_cmp_lg_u32 s3, 0
    s_cbranch_scc1 L_s_p
    v_mov_b32 v28, 0
    v_mov_b32 v29, 0
    v_mov_b32 v30, 0
    v_mov_b32 v31, 0
    v_lshrrev_b32 v1, 3, v0
    v_mul_u32_u24 v1, 128, v1
    v_and_b32 v2, 7, v0
    v_lshl_add_u32 v1, v2, 4, v1
    s_mul_i32 s13, s46, 1024
    s_add_u32 s13, s13, 29360128
    buffer_store_dwordx4 v[28:31], v1, s[60:63], s13 offen sc0 sc1
    s_branch L_s_p
L_s_nopub:
    s_waitcnt vmcnt(0) lgkmcnt(0)
    s_barrier
L_s_p:
    s_lshl_b32 s13, s14, 16
    s_and_b32 s15, s14, 0xffff0000
    s_bitcmp1_b32 s3, 0
    s_cselect_b32 s13, s15, s13
    v_mov_b32 v1, s13
    s_mov_b32 s15, 0x3fb8aa3b
    v_mul_f32 v2, s15, v1
    v_fma_f32 v3, v1, s15, -v2
    v_fmac_f32 v3, 0x32a5705f, v1
    v_exp_f32 v2, v2
    v_mul_f32 v3, 0x3f317218, v3
    v_fma_f32 v2, v2, v3, v2
    v_cvt_pk_bf16_f32 v2, v2, v2
    v_lshlrev_b32 v7, 16, v2
    v_lshlrev_b32 v1, 16, v72
    v_lshlrev_b32 v2, 16, v73
    v_mul_f32 v1, v7, v1
    v_mul_f32 v2, v7, v2
    v_mul_f32 v88, s15, v1
    v_mul_f32 v90, 0.15915494, v2
    v_lshlrev_b32 v44, 16, v74
    v_lshlrev_b32 v45, 16, v75
    v_lshlrev_b32 v40, 16, v76
    v_lshlrev_b32 v41, 16, v77
    v_and_b32 v1, 0xffff0000, v72
    v_and_b32 v2, 0xffff0000, v73
    v_mul_f32 v1, v7, v1
    v_mul_f32 v2, v7, v2
    v_mul_f32 v89, s15, v1
    v_mul_f32 v91, 0.15915494, v2
    v_and_b32 v46, 0xffff0000, v74
    v_and_b32 v47, 0xffff0000, v75
    v_and_b32 v42, 0xffff0000, v76
    v_and_b32 v43, 0xffff0000, v77
    v_mul_f32 v52, v40, v44
    v_mul_f32 v53, v40, v45
    v_mul_f32 v54, v42, v46
    v_mul_f32 v55, v42, v47
    v_fma_f32 v48, -v41, v45, v52
    v_fma_f32 v49, v41, v44, v53
    v_fma_f32 v50, -v43, v47, v54
    v_fma_f32 v51, v43, v46, v55
    v_max3_f32 v1, |v48|, |v49|, |v50|
    v_max_f32 v1, v1, |v51|
    s_nop 1
    v_max_f32_dpp v1, v1, v1 row_ror:8 row_mask:0xf bank_mask:0xf
    s_nop 1
    v_max_f32_dpp v1, v1, v1 row_ror:4 row_mask:0xf bank_mask:0xf
    s_nop 1
    v_max_f32_dpp v1, v1, v1 row_ror:2 row_mask:0xf bank_mask:0xf
    s_nop 1
    v_max_f32_dpp v1, v1, v1 row_ror:1 row_mask:0xf bank_mask:0xf
    s_nop 0
    v_readlane_b32 s10, v1, 0
    v_readlane_b32 s11, v1, 16
    v_readlane_b32 s12, v1, 32
    v_readlane_b32 s13, v1, 48
    s_nop 1
    s_max_u32 s10, s10, s11
    s_max_u32 s12, s12, s13
    s_max_u32 s10, s10, s12
    s_lshr_b32 s10, s10, 23
    s_max_u32 s10, s10, 1
    s_min_u32 s10, s10, 253
    s_sub_u32 s11, 254, s10
    s_lshl_b32 s10, s10, 23
    s_lshl_b32 s11, s11, 23
    v_mul_f32 v7, s10, v7
    v_mul_f32 v48, s11, v48
    v_mul_f32 v49, s11, -v49
    v_mul_f32 v50, s11, v50
    v_mul_f32 v51, s11, -v51
    v_mul_f32 v1, 0x41000000, v88
    v_mul_f32 v3, 0x41000000, v90
    v_mul_f32 v2, 0x41000000, v89
    v_mul_f32 v4, 0x41000000, v91
    v_exp_f32 v1, v1
    v_fract_f32 v3, v3
    v_exp_f32 v2, v2
    v_fract_f32 v4, v4
    v_cos_f32 v36, v3
    v_sin_f32 v37, v3
    v_cos_f32 v38, v4
    v_sin_f32 v39, v4
    s_nop 0
    v_mul_f32 v36, v1, v36
    v_mul_f32 v37, v1, -v37
    v_mul_f32 v38, v2, v38
    v_mul_f32 v39, v2, -v39
    v_mul_f32 v1, 0x3f800000, v88
    v_mul_f32 v3, 0x3f800000, v90
    v_mul_f32 v2, 0x3f800000, v89
    v_mul_f32 v4, 0x3f800000, v91
    v_exp_f32 v1, v1
    v_fract_f32 v3, v3
    v_exp_f32 v2, v2
    v_fract_f32 v4, v4
    v_cos_f32 v8, v3
    v_sin_f32 v9, v3
    v_cos_f32 v10, v4
    v_sin_f32 v11, v4
    s_nop 0
    v_mul_f32 v8, v1, v8
    v_mul_f32 v9, v1, v9
    v_mul_f32 v10, v2, v10
    v_mul_f32 v11, v2, v11
    v_mul_f32 v1, 0x43000000, v88
    v_mul_f32 v3, 0x43000000, v90
    v_mul_f32 v2, 0x43000000, v89
    v_mul_f32 v4, 0x43000000, v91
    v_exp_f32 v1, v1
    v_fract_f32 v3, v3
    v_exp_f32 v2, v2
    v_fract_f32 v4, v4
    v_cos_f32 v40, v3
    v_sin_f32 v41, v3
    v_cos_f32 v42, v4
    v_sin_f32 v43, v4
    s_nop 0
    v_mul_f32 v40, v1, v40
    v_mul_f32 v41, v1, v41
    v_mul_f32 v42, v2, v42
    v_mul_f32 v43, v2, v43
    v_mov_b32 v160, 0
    s_cmp_ge_u32 s46, 43
    s_cbranch_scc1 L_s_noat
    v_mov_b32 v1, 163808
    v_mov_b32 v161, 1
    s_mov_b64 exec, 1
    s_waitcnt vmcnt(0)
    ds_add_rtn_u32 v2, v1, v161
    s_waitcnt lgkmcnt(0)
    v_cmp_eq_u32 vcc, 11, v2
    s_and_b64 exec, exec, vcc
    global_atomic_add v160, v161, s[42:43] sc1
    s_mov_b64 exec, -1
L_s_noat:
    s_cmp_lg_u32 s5, 0
    s_cbranch_scc1 L_w1_11
    s_mov_b32 exec_hi, 0xffff
    buffer_load_dword v163, v159, s[52:55], s71 offen offset:768
    s_mov_b32 exec_hi, -1
    s_add_u32 s71, s71, 1769472
L_w1_11:
    v_lshl_add_u32 v5, v0, 3, s47
    v_and_b32 v1, 15, v0
    v_mul_u32_u24 v1, 528, v1
    v_lshrrev_b32 v2, 4, v0
    v_lshl_add_u32 v1, v2, 4, v1
    v_add_u32 v6, s47, v1
    v_cvt_pk_f16_f32 v76, v48, v49
    v_cvt_pk_f16_f32 v77, v50, v51
    ds_write_b64 v5, v[76:77] offset:0
    v_mul_f32 v52, v48, v36
    v_mul_f32 v53, v48, v37
    v_mul_f32 v54, v50, v38
    v_mul_f32 v55, v50, v39
    v_fma_f32 v48, -v49, v37, v52
    v_fma_f32 v49, v49, v36, v53
    v_fma_f32 v50, -v51, v39, v54
    v_fma_f32 v51, v51, v38, v55
    v_cvt_pk_f16_f32 v2, v48, v49
    v_cvt_pk_f16_f32 v3, v50, v51
    ds_write_b64 v5, v[2:3] offset:528
    v_mul_f32 v52, v48, v36
    v_mul_f32 v53, v48, v37
    v_mul_f32 v54, v50, v38
    v_mul_f32 v55, v50, v39
    v_fma_f32 v48, -v49, v37, v52
    v_fma_f32 v49, v49, v36, v53
    v_fma_f32 v50, -v51, v39, v54
    v_fma_f32 v51, v51, v38, v55
    v_cvt_pk_f16_f32 v76, v48, v49
    v_cvt_pk_f16_f32 v77, v50, v51
    ds_write_b64 v5, v[76:77] offset:1056
    v_mul_f32 v52, v48, v36
    v_mul_f32 v53, v48, v37
    v_mul_f32 v54, v50, v38
    v_mul_f32 v55, v50, v39
    v_fma_f32 v48, -v49, v37, v52
    v_fma_f32 v49, v49, v36, v53
    v_fma_f32 v50, -v51, v39, v54
    v_fma_f32 v51, v51, v38, v55
    v_cvt_pk_f16_f32 v2, v48, v49
    v_cvt_pk_f16_f32 v3, v50, v51
    ds_write_b64 v5, v[2:3] offset:1584
    v_mul_f32 v52, v48, v36
    v_mul_f32 v53, v48, v37
    v_mul_f32 v54, v50, v38
    v_mul_f32 v55, v50, v39
    v_fma_f32 v48, -v49, v37, v52
    v_fma_f32 v49, v49, v36, v53
    v_fma_f32 v50, -v51, v39, v54
    v_fma_f32 v51, v51, v38, v55
    v_cvt_pk_f16_f32 v76, v48, v49
    v_cvt_pk_f16_f32 v77, v50, v51
    ds_write_b64 v5, v[76:77] offset:2112
    v_mul_f32 v52, v48, v36
    v_mul_f32 v53, v48, v37
    v_mul_f32 v54, v50, v38
    v_mul_f32 v55, v50, v39
    v_fma_f32 v48, -v49, v37, v52
    v_fma_f32 v49, v49, v36, v53
    v_fma_f32 v50, -v51, v39, v54
    v_fma_f32 v51, v51, v38, v55
    v_cvt_pk_f16_f32 v2, v48, v49
    v_cvt_pk_f16_f32 v3, v50, v51
    ds_write_b64 v5, v[2:3] offset:2640
    v_mul_f32 v52, v48, v36
    v_mul_f32 v53, v48, v37
    v_mul_f32 v54, v50, v38
    v_mul_f32 v55, v50, v39
    v_fma_f32 v48, -v49, v37, v52
    v_fma_f32 v49, v49, v36, v53
    v_fma_f32 v50, -v51, v39, v54
    v_fma_f32 v51, v51, v38, v55
    v_cvt_pk_f16_f32 v76, v48, v49
    v_cvt_pk_f16_f32 v77, v50, v51
    ds_write_b64 v5, v[76:77] offset:3168
    v_mul_f32 v52, v48, v36
    v_mul_f32 v53, v48, v37
    v_mul_f32 v54, v50, v38
    v_mul_f32 v55, v50, v39
    v_fma_f32 v48, -v49, v37, v52
    v_fma_f32 v49, v49, v36, v53
    v_fma_f32 v50, -v51, v39, v54
    v_fma_f32 v51, v51, v38, v55
    v_cvt_pk_f16_f32 v2, v48, v49
    v_cvt_pk_f16_f32 v3, v50, v51
    ds_write_b64 v5, v[2:3] offset:3696
    v_mul_f32 v52, v48, v36
    v_mul_f32 v53, v48, v37
    v_mul_f32 v54, v50, v38
    v_mul_f32 v55, v50, v39
    v_fma_f32 v48, -v49, v37, v52
    v_fma_f32 v49, v49, v36, v53
    v_fma_f32 v50, -v51, v39, v54
    v_fma_f32 v51, v51, v38, v55
    v_cvt_pk_f16_f32 v76, v48, v49
    v_cvt_pk_f16_f32 v77, v50, v51
    ds_write_b64 v5, v[76:77] offset:4224
    v_mul_f32 v52, v48, v36
    v_mul_f32 v53, v48, v37
    v_mul_f32 v54, v50, v38
    v_mul_f32 v55, v50, v39
    v_fma_f32 v48, -v49, v37, v52
    v_fma_f32 v49, v49, v36, v53
    v_fma_f32 v50, -v51, v39, v54
    v_fma_f32 v51, v51, v38, v55
    v_cvt_pk_f16_f32 v2, v48, v49
    v_cvt_pk_f16_f32 v3, v50, v51
    ds_write_b64 v5, v[2:3] offset:4752
    v_mul_f32 v52, v48, v36
    v_mul_f32 v53, v48, v37
    v_mul_f32 v54, v50, v38
    v_mul_f32 v55, v50, v39
    v_fma_f32 v48, -v49, v37, v52
    v_fma_f32 v49, v49, v36, v53
    v_fma_f32 v50, -v51, v39, v54
    v_fma_f32 v51, v51, v38, v55
    v_cvt_pk_f16_f32 v76, v48, v49
    v_cvt_pk_f16_f32 v77, v50, v51
    ds_write_b64 v5, v[76:77] offset:5280
    v_mul_f32 v52, v48, v36
    v_mul_f32 v53, v48, v37
    v_mul_f32 v54, v50, v38
    v_mul_f32 v55, v50, v39
    v_fma_f32 v48, -v49, v37, v52
    v_fma_f32 v49, v49, v36, v53
    v_fma_f32 v50, -v51, v39, v54
    v_fma_f32 v51, v51, v38, v55
    v_cvt_pk_f16_f32 v2, v48, v49
    v_cvt_pk_f16_f32 v3, v50, v51
    ds_write_b64 v5, v[2:3] offset:5808
    v_mul_f32 v52, v48, v36
    v_mul_f32 v53, v48, v37
    v_mul_f32 v54, v50, v38
    v_mul_f32 v55, v50, v39
    v_fma_f32 v48, -v49, v37, v52
    v_fma_f32 v49, v49, v36, v53
    v_fma_f32 v50, -v51, v39, v54
    v_fma_f32 v51, v51, v38, v55
    v_cvt_pk_f16_f32 v76, v48, v49
    v_cvt_pk_f16_f32 v77, v50, v51
    ds_write_b64 v5, v[76:77] offset:6336
    v_mul_f32 v52, v48, v36
    v_mul_f32 v53, v48, v37
    v_mul_f32 v54, v50, v38
    v_mul_f32 v55, v50, v39
    v_fma_f32 v48, -v49, v37, v52
    v_fma_f32 v49, v49, v36, v53
    v_fma_f32 v50, -v51, v39, v54
    v_fma_f32 v51, v51, v38, v55
    v_cvt_pk_f16_f32 v2, v48, v49
    v_cvt_pk_f16_f32 v3, v50, v51
    ds_write_b64 v5, v[2:3] offset:6864
    v_mul_f32 v52, v48, v36
    v_mul_f32 v53, v48, v37
    v_mul_f32 v54, v50, v38
    v_mul_f32 v55, v50, v39
    v_fma_f32 v48, -v49, v37, v52
    v_fma_f32 v49, v49, v36, v53
    v_fma_f32 v50, -v51, v39, v54
    v_fma_f32 v51, v51, v38, v55
    v_cvt_pk_f16_f32 v76, v48, v49
    v_cvt_pk_f16_f32 v77, v50, v51
    ds_write_b64 v5, v[76:77] offset:7392
    v_mul_f32 v52, v48, v36
    v_mul_f32 v53, v48, v37
    v_mul_f32 v54, v50, v38
    v_mul_f32 v55, v50, v39
    v_fma_f32 v48, -v49, v37, v52
    v_fma_f32 v49, v49, v36, v53
    v_fma_f32 v50, -v51, v39, v54
    v_fma_f32 v51, v51, v38, v55
    v_cvt_pk_f16_f32 v2, v48, v49
    v_cvt_pk_f16_f32 v3, v50, v51
    ds_write_b64 v5, v[2:3] offset:7920
    ds_read_b128 v[92:95], v6 offset:0
    ds_read_b128 v[96:99], v6 offset:64
    ds_read_b128 v[100:103], v6 offset:128
    ds_read_b128 v[104:107], v6 offset:192
    ds_read_b128 v[108:111], v6 offset:256
    ds_read_b128 v[112:115], v6 offset:320
    ds_read_b128 v[116:119], v6 offset:384
    ds_read_b128 v[120:123], v6 offset:448
    s_cmp_lg_u32 s5, 0
    s_cbranch_scc1 L_w1_12
    s_mov_b32 exec_hi, 0xffff
    buffer_load_dword v163, v159, s[52:55], s71 offen offset:768
    s_mov_b32 exec_hi, -1
    s_add_u32 s71, s71, 1769472
L_w1_12:
    v_mov_b32 v2, 0x3c00
    v_mov_b32 v3, 0x3c00
    ds_write_b64 v5, v[2:3]
    v_cvt_pk_f16_f32 v76, v8, v9
    v_cvt_pk_f16_f32 v77, v10, v11
    ds_write_b64 v5, v[76:77] offset:528
    v_mul_f32 v52, v8, v8
    v_mul_f32 v53, v8, v9
    v_mul_f32 v54, v10, v10
    v_mul_f32 v55, v10, v11
    v_fma_f32 v12, -v9, v9, v52
    v_fma_f32 v13, v9, v8, v53
    v_fma_f32 v14, -v11, v11, v54
    v_fma_f32 v15, v11, v10, v55
    v_cvt_pk_f16_f32 v2, v12, v13
    v_cvt_pk_f16_f32 v3, v14, v15
    ds_write_b64 v5, v[2:3] offset:1056
    v_mul_f32 v52, v12, v8
    v_mul_f32 v53, v12, v9
    v_mul_f32 v54, v14, v10
    v_mul_f32 v55, v14, v11
    v_fma_f32 v16, -v13, v9, v52
    v_fma_f32 v17, v13, v8, v53
    v_fma_f32 v18, -v15, v11, v54
    v_fma_f32 v19, v15, v10, v55
    v_cvt_pk_f16_f32 v76, v16, v17
    v_cvt_pk_f16_f32 v77, v18, v19
    ds_write_b64 v5, v[76:77] offset:1584
    v_mul_f32 v52, v12, v12
    v_mul_f32 v53, v12, v13
    v_mul_f32 v54, v14, v14
    v_mul_f32 v55, v14, v15
    v_fma_f32 v20, -v13, v13, v52
    v_fma_f32 v21, v13, v12, v53
    v_fma_f32 v22, -v15, v15, v54
    v_fma_f32 v23, v15, v14, v55
    v_cvt_pk_f16_f32 v2, v20, v21
    v_cvt_pk_f16_f32 v3, v22, v23
    ds_write_b64 v5, v[2:3] offset:2112
    v_mul_f32 v52, v20, v8
    v_mul_f32 v53, v20, v9
    v_mul_f32 v54, v22, v10
    v_mul_f32 v55, v22, v11
    v_fma_f32 v24, -v21, v9, v52
    v_fma_f32 v25, v21, v8, v53
    v_fma_f32 v26, -v23, v11, v54
    v_fma_f32 v27, v23, v10, v55
    v_cvt_pk_f16_f32 v76, v24, v25
    v_cvt_pk_f16_f32 v77, v26, v27
    ds_write_b64 v5, v[76:77] offset:2640
    v_mul_f32 v52, v20, v12
    v_mul_f32 v53, v20, v13
    v_mul_f32 v54, v22, v14
    v_mul_f32 v55, v22, v15
    v_fma_f32 v28, -v21, v13, v52
    v_fma_f32 v29, v21, v12, v53
    v_fma_f32 v30, -v23, v15, v54
    v_fma_f32 v31, v23, v14, v55
    v_cvt_pk_f16_f32 v2, v28, v29
    v_cvt_pk_f16_f32 v3, v30, v31
    ds_write_b64 v5, v[2:3] offset:3168
    v_mul_f32 v52, v20, v16
    v_mul_f32 v53, v20, v17
    v_mul_f32 v54, v22, v18
    v_mul_f32 v55, v22, v19
    v_fma_f32 v32, -v21, v17, v52
    v_fma_f32 v33, v21, v16, v53
    v_fma_f32 v34, -v23, v19, v54
    v_fma_f32 v35, v23, v18, v55
    v_cvt_pk_f16_f32 v76, v32, v33
    v_cvt_pk_f16_f32 v77, v34, v35
    ds_write_b64 v5, v[76:77] offset:3696
    v_cvt_pk_f16_f32 v2, v40, v41
    v_cvt_pk_f16_f32 v3, v42, v43
    ds_write_b64 v5, v[2:3] offset:4224
    v_mul_f32 v52, v40, v8
    v_mul_f32 v53, v40, v9
    v_mul_f32 v54, v42, v10
    v_mul_f32 v55, v42, v11
    v_fma_f32 v48, -v41, v9, v52
    v_fma_f32 v49, v41, v8, v53
    v_fma_f32 v50, -v43, v11, v54
    v_fma_f32 v51, v43, v10, v55
    v_cvt_pk_f16_f32 v76, v48, v49
    v_cvt_pk_f16_f32 v77, v50, v51
    ds_write_b64 v5, v[76:77] offset:4752
    v_mul_f32 v52, v40, v12
    v_mul_f32 v53, v40, v13
    v_mul_f32 v54, v42, v14
    v_mul_f32 v55, v42, v15
    v_fma_f32 v48, -v41, v13, v52
    v_fma_f32 v49, v41, v12, v53
    v_fma_f32 v50, -v43, v15, v54
    v_fma_f32 v51, v43, v14, v55
    v_cvt_pk_f16_f32 v2, v48, v49
    v_cvt_pk_f16_f32 v3, v50, v51
    ds_write_b64 v5, v[2:3] offset:5280
    v_mul_f32 v52, v40, v16
    v_mul_f32 v53, v40, v17
    v_mul_f32 v54, v42, v18
    v_mul_f32 v55, v42, v19
    v_fma_f32 v48, -v41, v17, v52
    v_fma_f32 v49, v41, v16, v53
    v_fma_f32 v50, -v43, v19, v54
    v_fma_f32 v51, v43, v18, v55
    v_cvt_pk_f16_f32 v76, v48, v49
    v_cvt_pk_f16_f32 v77, v50, v51
    ds_write_b64 v5, v[76:77] offset:5808
    v_mul_f32 v52, v40, v20
    v_mul_f32 v53, v40, v21
    v_mul_f32 v54, v42, v22
    v_mul_f32 v55, v42, v23
    v_fma_f32 v48, -v41, v21, v52
    v_fma_f32 v49, v41, v20, v53
    v_fma_f32 v50, -v43, v23, v54
    v_fma_f32 v51, v43, v22, v55
    v_cvt_pk_f16_f32 v2, v48, v49
    v_cvt_pk_f16_f32 v3, v50, v51
    ds_write_b64 v5, v[2:3] offset:6336
    v_mul_f32 v52, v40, v24
    v_mul_f32 v53, v40, v25
    v_mul_f32 v54, v42, v26
    v_mul_f32 v55, v42, v27
    v_fma_f32 v48, -v41, v25, v52
    v_fma_f32 v49, v41, v24, v53
    v_fma_f32 v50, -v43, v27, v54
    v_fma_f32 v51, v43, v26, v55
    v_cvt_pk_f16_f32 v76, v48, v49
    v_cvt_pk_f16_f32 v77, v50, v51
    ds_write_b64 v5, v[76:77] offset:6864
    v_mul_f32 v52, v40, v28
    v_mul_f32 v53, v40, v29
    v_mul_f32 v54, v42, v30
    v_mul_f32 v55, v42, v31
    v_fma_f32 v48, -v41, v29, v52
    v_fma_f32 v49, v41, v28, v53
    v_fma_f32 v50, -v43, v31, v54
    v_fma_f32 v51, v43, v30, v55
    v_cvt_pk_f16_f32 v2, v48, v49
    v_cvt_pk_f16_f32 v3, v50, v51
    ds_write_b64 v5, v[2:3] offset:7392
    v_mul_f32 v52, v40, v32
    v_mul_f32 v53, v40, v33
    v_mul_f32 v54, v42, v34
    v_mul_f32 v55, v42, v35
    v_fma_f32 v48, -v41, v33, v52
    v_fma_f32 v49, v41, v32, v53
    v_fma_f32 v50, -v43, v35, v54
    v_fma_f32 v51, v43, v34, v55
    v_cvt_pk_f16_f32 v76, v48, v49
    v_cvt_pk_f16_f32 v77, v50, v51
    ds_write_b64 v5, v[76:77] offset:7920
    ds_read_b128 v[124:127], v6 offset:0
    ds_read_b128 v[128:131], v6 offset:64
    ds_read_b128 v[132:135], v6 offset:128
    ds_read_b128 v[136:139], v6 offset:192
    ds_read_b128 v[56:59], v6 offset:256
    ds_read_b128 v[60:63], v6 offset:320
    ds_read_b128 v[64:67], v6 offset:384
    ds_read_b128 v[68:71], v6 offset:448
    s_waitcnt lgkmcnt(7)
    v_mfma_f32_16x16x32_f16 v[164:167], v[124:127], v[92:95], 0
    s_waitcnt lgkmcnt(6)
    v_mfma_f32_16x16x32_f16 v[164:167], v[128:131], v[96:99], v[164:167]
    s_waitcnt lgkmcnt(5)
    v_mfma_f32_16x16x32_f16 v[164:167], v[132:135], v[100:103], v[164:167]
    s_waitcnt lgkmcnt(4)
    v_mfma_f32_16x16x32_f16 v[164:167], v[136:139], v[104:107], v[164:167]
    s_waitcnt lgkmcnt(3)
    v_mfma_f32_16x16x32_f16 v[164:167], v[56:59], v[108:111], v[164:167]
    s_waitcnt lgkmcnt(2)
    v_mfma_f32_16x16x32_f16 v[164:167], v[60:63], v[112:115], v[164:167]
    s_waitcnt lgkmcnt(1)
    v_mfma_f32_16x16x32_f16 v[164:167], v[64:67], v[116:119], v[164:167]
    s_waitcnt lgkmcnt(0)
    v_mfma_f32_16x16x32_f16 v[164:167], v[68:71], v[120:123], v[164:167]
    s_cmp_lg_u32 s5, 0
    s_cbranch_scc1 L_w1_13
    s_mov_b32 exec_hi, 0xffff
    buffer_load_dword v163, v159, s[52:55], s71 offen offset:768
    s_mov_b32 exec_hi, -1
    s_add_u32 s71, s71, 1769472
L_w1_13:
    v_mul_f32 v52, v40, v40
    v_mul_f32 v53, v40, v41
    v_mul_f32 v54, v42, v42
    v_mul_f32 v55, v42, v43
    v_fma_f32 v44, -v41, v41, v52
    v_fma_f32 v45, v41, v40, v53
    v_fma_f32 v46, -v43, v43, v54
    v_fma_f32 v47, v43, v42, v55
    v_cvt_pk_f16_f32 v2, v44, v45
    v_cvt_pk_f16_f32 v3, v46, v47
    ds_write_b64 v5, v[2:3] offset:0
    v_mul_f32 v52, v44, v12
    v_mul_f32 v53, v44, v13
    v_mul_f32 v54, v46, v14
    v_mul_f32 v55, v46, v15
    v_fma_f32 v48, -v45, v13, v52
    v_fma_f32 v49, v45, v12, v53
    v_fma_f32 v50, -v47, v15, v54
    v_fma_f32 v51, v47, v14, v55
    v_cvt_pk_f16_f32 v76, v48, v49
    v_cvt_pk_f16_f32 v77, v50, v51
    ds_write_b64 v5, v[76:77] offset:528
    v_mul_f32 v52, v44, v20
    v_mul_f32 v53, v44, v21
    v_mul_f32 v54, v46, v22
    v_mul_f32 v55, v46, v23
    v_fma_f32 v48, -v45, v21, v52
    v_fma_f32 v49, v45, v20, v53
    v_fma_f32 v50, -v47, v23, v54
    v_fma_f32 v51, v47, v22, v55
    v_cvt_pk_f16_f32 v2, v48, v49
    v_cvt_pk_f16_f32 v3, v50, v51
    ds_write_b64 v5, v[2:3] offset:1056
    v_mul_f32 v52, v44, v28
    v_mul_f32 v53, v44, v29
    v_mul_f32 v54, v46, v30
    v_mul_f32 v55, v46, v31
    v_fma_f32 v48, -v45, v29, v52
    v_fma_f32 v49, v45, v28, v53
    v_fma_f32 v50, -v47, v31, v54
    v_fma_f32 v51, v47, v30, v55
    v_cvt_pk_f16_f32 v76, v48, v49
    v_cvt_pk_f16_f32 v77, v50, v51
    ds_write_b64 v5, v[76:77] offset:1584
    v_mul_f32 v52, v44, v40
    v_mul_f32 v53, v44, v41
    v_mul_f32 v54, v46, v42
    v_mul_f32 v55, v46, v43
    v_fma_f32 v44, -v45, v41, v52
    v_fma_f32 v45, v45, v40, v53
    v_fma_f32 v46, -v47, v43, v54
    v_fma_f32 v47, v47, v42, v55
    v_cvt_pk_f16_f32 v2, v44, v45
    v_cvt_pk_f16_f32 v3, v46, v47
    ds_write_b64 v5, v[2:3] offset:2112
    v_mul_f32 v52, v44, v12
    v_mul_f32 v53, v44, v13
    v_mul_f32 v54, v46, v14
    v_mul_f32 v55, v46, v15
    v_fma_f32 v48, -v45, v13, v52
    v_fma_f32 v49, v45, v12, v53
    v_fma_f32 v50, -v47, v15, v54
    v_fma_f32 v51, v47, v14, v55
    v_cvt_pk_f16_f32 v76, v48, v49
    v_cvt_pk_f16_f32 v77, v50, v51
    ds_write_b64 v5, v[76:77] offset:2640
    v_mul_f32 v52, v44, v20
    v_mul_f32 v53, v44, v21
    v_mul_f32 v54, v46, v22
    v_mul_f32 v55, v46, v23
    v_fma_f32 v48, -v45, v21, v52
    v_fma_f32 v49, v45, v20, v53
    v_fma_f32 v50, -v47, v23, v54
    v_fma_f32 v51, v47, v22, v55
    v_cvt_pk_f16_f32 v2, v48, v49
    v_cvt_pk_f16_f32 v3, v50, v51
    ds_write_b64 v5, v[2:3] offset:3168
    v_mul_f32 v52, v44, v28
    v_mul_f32 v53, v44, v29
    v_mul_f32 v54, v46, v30
    v_mul_f32 v55, v46, v31
    v_fma_f32 v48, -v45, v29, v52
    v_fma_f32 v49, v45, v28, v53
    v_fma_f32 v50, -v47, v31, v54
    v_fma_f32 v51, v47, v30, v55
    v_cvt_pk_f16_f32 v76, v48, v49
    v_cvt_pk_f16_f32 v77, v50, v51
    ds_write_b64 v5, v[76:77] offset:3696
    v_mul_f32 v52, v44, v40
    v_mul_f32 v53, v44, v41
    v_mul_f32 v54, v46, v42
    v_mul_f32 v55, v46, v43
    v_fma_f32 v44, -v45, v41, v52
    v_fma_f32 v45, v45, v40, v53
    v_fma_f32 v46, -v47, v43, v54
    v_fma_f32 v47, v47, v42, v55
    v_cvt_pk_f16_f32 v2, v44, v45
    v_cvt_pk_f16_f32 v3, v46, v47
    ds_write_b64 v5, v[2:3] offset:4224
    v_mul_f32 v52, v44, v20
    v_mul_f32 v53, v44, v21
    v_mul_f32 v54, v46, v22
    v_mul_f32 v55, v46, v23
    v_fma_f32 v48, -v45, v21, v52
    v_fma_f32 v49, v45, v20, v53
    v_fma_f32 v50, -v47, v23, v54
    v_fma_f32 v51, v47, v22, v55
    v_cvt_pk_f16_f32 v76, v48, v49
    v_cvt_pk_f16_f32 v77, v50, v51
    ds_write_b64 v5, v[76:77] offset:4752
    v_mul_f32 v52, v44, v40
    v_mul_f32 v53, v44, v41
    v_mul_f32 v54, v46, v42
    v_mul_f32 v55, v46, v43
    v_fma_f32 v44, -v45, v41, v52
    v_fma_f32 v45, v45, v40, v53
    v_fma_f32 v46, -v47, v43, v54
    v_fma_f32 v47, v47, v42, v55
    v_cvt_pk_f16_f32 v2, v44, v45
    v_cvt_pk_f16_f32 v3, v46, v47
    ds_write_b64 v5, v[2:3] offset:5280
    v_mul_f32 v52, v44, v20
    v_mul_f32 v53, v44, v21
    v_mul_f32 v54, v46, v22
    v_mul_f32 v55, v46, v23
    v_fma_f32 v48, -v45, v21, v52
    v_fma_f32 v49, v45, v20, v53
    v_fma_f32 v50, -v47, v23, v54
    v_fma_f32 v51, v47, v22, v55
    v_cvt_pk_f16_f32 v76, v48, v49
    v_cvt_pk_f16_f32 v77, v50, v51
    ds_write_b64 v5, v[76:77] offset:5808
    v_mul_f32 v52, v44, v40
    v_mul_f32 v53, v44, v41
    v_mul_f32 v54, v46, v42
    v_mul_f32 v55, v46, v43
    v_fma_f32 v44, -v45, v41, v52
    v_fma_f32 v45, v45, v40, v53
    v_fma_f32 v46, -v47, v43, v54
    v_fma_f32 v47, v47, v42, v55
    v_cvt_pk_f16_f32 v2, v44, v45
    v_cvt_pk_f16_f32 v3, v46, v47
    ds_write_b64 v5, v[2:3] offset:6336
    v_mul_f32 v52, v44, v20
    v_mul_f32 v53, v44, v21
    v_mul_f32 v54, v46, v22
    v_mul_f32 v55, v46, v23
    v_fma_f32 v48, -v45, v21, v52
    v_fma_f32 v49, v45, v20, v53
    v_fma_f32 v50, -v47, v23, v54
    v_fma_f32 v51, v47, v22, v55
    v_cvt_pk_f16_f32 v76, v48, v49
    v_cvt_pk_f16_f32 v77, v50, v51
    ds_write_b64 v5, v[76:77] offset:6864
    v_mul_f32 v52, v44, v40
    v_mul_f32 v53, v44, v41
    v_mul_f32 v54, v46, v42
    v_mul_f32 v55, v46, v43
    v_fma_f32 v44, -v45, v41, v52
    v_fma_f32 v45, v45, v40, v53
    v_fma_f32 v46, -v47, v43, v54
    v_fma_f32 v47, v47, v42, v55
    v_cvt_pk_f16_f32 v2, v44, v45
    v_cvt_pk_f16_f32 v3, v46, v47
    ds_write_b64 v5, v[2:3] offset:7392
    v_mul_f32 v52, v44, v20
    v_mul_f32 v53, v44, v21
    v_mul_f32 v54, v46, v22
    v_mul_f32 v55, v46, v23
    v_fma_f32 v48, -v45, v21, v52
    v_fma_f32 v49, v45, v20, v53
    v_fma_f32 v50, -v47, v23, v54
    v_fma_f32 v51, v47, v22, v55
    v_cvt_pk_f16_f32 v76, v48, v49
    v_cvt_pk_f16_f32 v77, v50, v51
    ds_write_b64 v5, v[76:77] offset:7920
    ds_read_b128 v[124:127], v6 offset:0
    ds_read_b128 v[128:131], v6 offset:64
    ds_read_b128 v[132:135], v6 offset:128
    ds_read_b128 v[136:139], v6 offset:192
    ds_read_b128 v[56:59], v6 offset:256
    ds_read_b128 v[60:63], v6 offset:320
    ds_read_b128 v[64:67], v6 offset:384
    ds_read_b128 v[68:71], v6 offset:448
    s_waitcnt lgkmcnt(7)
    v_mfma_f32_16x16x32_f16 v[72:75], v[124:127], v[92:95], 0
    s_waitcnt lgkmcnt(6)
    v_mfma_f32_16x16x32_f16 v[72:75], v[128:131], v[96:99], v[72:75]
    s_waitcnt lgkmcnt(5)
    v_mfma_f32_16x16x32_f16 v[72:75], v[132:135], v[100:103], v[72:75]
    s_waitcnt lgkmcnt(4)
    v_mfma_f32_16x16x32_f16 v[72:75], v[136:139], v[104:107], v[72:75]
    s_waitcnt lgkmcnt(3)
    v_mfma_f32_16x16x32_f16 v[72:75], v[56:59], v[108:111], v[72:75]
    s_waitcnt lgkmcnt(2)
    v_mfma_f32_16x16x32_f16 v[72:75], v[60:63], v[112:115], v[72:75]
    s_waitcnt lgkmcnt(1)
    v_mfma_f32_16x16x32_f16 v[72:75], v[64:67], v[116:119], v[72:75]
    s_waitcnt lgkmcnt(0)
    v_mfma_f32_16x16x32_f16 v[72:75], v[68:71], v[120:123], v[72:75]
    v_mul_f32 v52, v44, v40
    v_mul_f32 v53, v44, v41
    v_mul_f32 v54, v46, v42
    v_mul_f32 v55, v46, v43
    v_fma_f32 v44, -v45, v41, v52
    v_fma_f32 v45, v45, v40, v53
    v_fma_f32 v46, -v47, v43, v54
    v_fma_f32 v47, v47, v42, v55
    v_cvt_pk_f16_f32 v2, v44, v45
    v_cvt_pk_f16_f32 v3, v46, v47
    ds_write_b64 v5, v[2:3] offset:0
    v_mul_f32 v52, v44, v40
    v_mul_f32 v53, v44, v41
    v_mul_f32 v54, v46, v42
    v_mul_f32 v55, v46, v43
    v_fma_f32 v44, -v45, v41, v52
    v_fma_f32 v45, v45, v40, v53
    v_fma_f32 v46, -v47, v43, v54
    v_fma_f32 v47, v47, v42, v55
    v_cvt_pk_f16_f32 v76, v44, v45
    v_cvt_pk_f16_f32 v77, v46, v47
    ds_write_b64 v5, v[76:77] offset:528
    v_mul_f32 v52, v44, v40
    v_mul_f32 v53, v44, v41
    v_mul_f32 v54, v46, v42
    v_mul_f32 v55, v46, v43
    v_fma_f32 v44, -v45, v41, v52
    v_fma_f32 v45, v45, v40, v53
    v_fma_f32 v46, -v47, v43, v54
    v_fma_f32 v47, v47, v42, v55
    v_cvt_pk_f16_f32 v2, v44, v45
    v_cvt_pk_f16_f32 v3, v46, v47
    ds_write_b64 v5, v[2:3] offset:1056
    v_mul_f32 v52, v44, v40
    v_mul_f32 v53, v44, v41
    v_mul_f32 v54, v46, v42
    v_mul_f32 v55, v46, v43
    v_fma_f32 v44, -v45, v41, v52
    v_fma_f32 v45, v45, v40, v53
    v_fma_f32 v46, -v47, v43, v54
    v_fma_f32 v47, v47, v42, v55
    v_cvt_pk_f16_f32 v76, v44, v45
    v_cvt_pk_f16_f32 v77, v46, v47
    ds_write_b64 v5, v[76:77] offset:1584
    v_mul_f32 v52, v44, v40
    v_mul_f32 v53, v44, v41
    v_mul_f32 v54, v46, v42
    v_mul_f32 v55, v46, v43
    v_fma_f32 v44, -v45, v41, v52
    v_fma_f32 v45, v45, v40, v53
    v_fma_f32 v46, -v47, v43, v54
    v_fma_f32 v47, v47, v42, v55
    v_cvt_pk_f16_f32 v2, v44, v45
    v_cvt_pk_f16_f32 v3, v46, v47
    ds_write_b64 v5, v[2:3] offset:2112
    v_mul_f32 v52, v44, v40
    v_mul_f32 v53, v44, v41
    v_mul_f32 v54, v46, v42
    v_mul_f32 v55, v46, v43
    v_fma_f32 v44, -v45, v41, v52
    v_fma_f32 v45, v45, v40, v53
    v_fma_f32 v46, -v47, v43, v54
    v_fma_f32 v47, v47, v42, v55
    v_cvt_pk_f16_f32 v76, v44, v45
    v_cvt_pk_f16_f32 v77, v46, v47
    ds_write_b64 v5, v[76:77] offset:2640
    v_mul_f32 v52, v44, v40
    v_mul_f32 v53, v44, v41
    v_mul_f32 v54, v46, v42
    v_mul_f32 v55, v46, v43
    v_fma_f32 v44, -v45, v41, v52
    v_fma_f32 v45, v45, v40, v53
    v_fma_f32 v46, -v47, v43, v54
    v_fma_f32 v47, v47, v42, v55
    v_cvt_pk_f16_f32 v2, v44, v45
    v_cvt_pk_f16_f32 v3, v46, v47
    ds_write_b64 v5, v[2:3] offset:3168
    v_mul_f32 v52, v44, v40
    v_mul_f32 v53, v44, v41
    v_mul_f32 v54, v46, v42
    v_mul_f32 v55, v46, v43
    v_fma_f32 v44, -v45, v41, v52
    v_fma_f32 v45, v45, v40, v53
    v_fma_f32 v46, -v47, v43, v54
    v_fma_f32 v47, v47, v42, v55
    v_cvt_pk_f16_f32 v76, v44, v45
    v_cvt_pk_f16_f32 v77, v46, v47
    ds_write_b64 v5, v[76:77] offset:3696
    v_mul_f32 v52, v44, v40
    v_mul_f32 v53, v44, v41
    v_mul_f32 v54, v46, v42
    v_mul_f32 v55, v46, v43
    v_fma_f32 v44, -v45, v41, v52
    v_fma_f32 v45, v45, v40, v53
    v_fma_f32 v46, -v47, v43, v54
    v_fma_f32 v47, v47, v42, v55
    v_cvt_pk_f16_f32 v2, v44, v45
    v_cvt_pk_f16_f32 v3, v46, v47
    ds_write_b64 v5, v[2:3] offset:4224
    ds_read_b128 v[124:127], v6 offset:0
    ds_read_b128 v[128:131], v6 offset:64
    ds_read_b128 v[132:135], v6 offset:128
    ds_read_b128 v[136:139], v6 offset:192
    ds_read_b128 v[56:59], v6 offset:256
    ds_read_b128 v[60:63], v6 offset:320
    ds_read_b128 v[64:67], v6 offset:384
    ds_read_b128 v[68:71], v6 offset:448
    s_waitcnt lgkmcnt(7)
    v_mfma_f32_16x16x32_f16 v[88:91], v[124:127], v[92:95], 0
    s_waitcnt lgkmcnt(6)
    v_mfma_f32_16x16x32_f16 v[88:91], v[128:131], v[96:99], v[88:91]
    s_waitcnt lgkmcnt(5)
    v_mfma_f32_16x16x32_f16 v[88:91], v[132:135], v[100:103], v[88:91]
    s_waitcnt lgkmcnt(4)
    v_mfma_f32_16x16x32_f16 v[88:91], v[136:139], v[104:107], v[88:91]
    s_waitcnt lgkmcnt(3)
    v_mfma_f32_16x16x32_f16 v[88:91], v[56:59], v[108:111], v[88:91]
    s_waitcnt lgkmcnt(2)
    v_mfma_f32_16x16x32_f16 v[88:91], v[60:63], v[112:115], v[88:91]
    s_waitcnt lgkmcnt(1)
    v_mfma_f32_16x16x32_f16 v[88:91], v[64:67], v[116:119], v[88:91]
    s_waitcnt lgkmcnt(0)
    v_mfma_f32_16x16x32_f16 v[88:91], v[68:71], v[120:123], v[88:91]
    v_and_b32 v1, 15, v0
    v_lshrrev_b32 v2, 4, v0
    v_lshlrev_b32 v2, 7, v2
    v_lshl_add_u32 v1, v1, 1, v2
    s_add_u32 s13, s47, 0
    v_add_u32 v1, s13, v1
    v_mov_b32 v4, s13
    s_nop 3
    v_mul_f32 v164, v7, v164
    v_mul_f32 v165, v7, v165
    v_mul_f32 v166, v7, v166
    v_mul_f32 v167, v7, v167
    v_cvt_pk_bf16_f32 v164, v164, v165
    v_cvt_pk_bf16_f32 v166, v166, v167
    ds_write_b16 v1, v164 offset:0
    ds_write_b16_d16_hi v1, v164 offset:32
    ds_write_b16 v1, v166 offset:64
    ds_write_b16_d16_hi v1, v166 offset:96
    v_mul_f32 v72, v7, v72
    v_mul_f32 v73, v7, v73
    v_mul_f32 v74, v7, v74
    v_mul_f32 v75, v7, v75
    v_cvt_pk_bf16_f32 v72, v72, v73
    v_cvt_pk_bf16_f32 v74, v74, v75
    ds_write_b16 v1, v72 offset:512
    ds_write_b16_d16_hi v1, v72 offset:544
    ds_write_b16 v1, v74 offset:576
    ds_write_b16_d16_hi v1, v74 offset:608
    v_mul_f32 v88, v7, v88
    v_mul_f32 v89, v7, v89
    v_mul_f32 v90, v7, v90
    v_mul_f32 v91, v7, v91
    v_cvt_pk_bf16_f32 v88, v88, v89
    v_cvt_pk_bf16_f32 v90, v90, v91
    ds_write_b16 v1, v88 offset:1024
    ds_write_b16_d16_hi v1, v88 offset:1056
    ds_write_b16 v1, v90 offset:1088
    ds_write_b16_d16_hi v1, v90 offset:1120
    v_mov_b32 v2, 0
    v_mov_b32 v3, 0
    ds_write_b32 v4, v2 offset:1504
    v_add_u32_sdwa v8, v78, v4 dst_sel:DWORD dst_unused:UNUSED_PAD src0_sel:WORD_0 src1_sel:DWORD
    v_add_u32_sdwa v9, v78, v4 dst_sel:DWORD dst_unused:UNUSED_PAD src0_sel:WORD_1 src1_sel:DWORD
    v_add_u32_sdwa v10, v79, v4 dst_sel:DWORD dst_unused:UNUSED_PAD src0_sel:WORD_0 src1_sel:DWORD
    v_add_u32_sdwa v11, v79, v4 dst_sel:DWORD dst_unused:UNUSED_PAD src0_sel:WORD_1 src1_sel:DWORD
    v_add_u32_sdwa v12, v80, v4 dst_sel:DWORD dst_unused:UNUSED_PAD src0_sel:WORD_0 src1_sel:DWORD
    v_add_u32_sdwa v13, v80, v4 dst_sel:DWORD dst_unused:UNUSED_PAD src0_sel:WORD_1 src1_sel:DWORD
    v_add_u32_sdwa v14, v81, v4 dst_sel:DWORD dst_unused:UNUSED_PAD src0_sel:WORD_0 src1_sel:DWORD
    v_add_u32_sdwa v15, v81, v4 dst_sel:DWORD dst_unused:UNUSED_PAD src0_sel:WORD_1 src1_sel:DWORD
    v_add_u32_sdwa v16, v82, v4 dst_sel:DWORD dst_unused:UNUSED_PAD src0_sel:WORD_0 src1_sel:DWORD
    v_add_u32_sdwa v17, v82, v4 dst_sel:DWORD dst_unused:UNUSED_PAD src0_sel:WORD_1 src1_sel:DWORD
    v_add_u32_sdwa v18, v83, v4 dst_sel:DWORD dst_unused:UNUSED_PAD src0_sel:WORD_0 src1_sel:DWORD
    v_add_u32_sdwa v19, v83, v4 dst_sel:DWORD dst_unused:UNUSED_PAD src0_sel:WORD_1 src1_sel:DWORD
    v_add_u32_sdwa v20, v84, v4 dst_sel:DWORD dst_unused:UNUSED_PAD src0_sel:WORD_0 src1_sel:DWORD
    v_add_u32_sdwa v21, v84, v4 dst_sel:DWORD dst_unused:UNUSED_PAD src0_sel:WORD_1 src1_sel:DWORD
    v_add_u32_sdwa v22, v85, v4 dst_sel:DWORD dst_unused:UNUSED_PAD src0_sel:WORD_0 src1_sel:DWORD
    v_add_u32_sdwa v23, v85, v4 dst_sel:DWORD dst_unused:UNUSED_PAD src0_sel:WORD_1 src1_sel:DWORD
    v_add_u32_sdwa v24, v86, v4 dst_sel:DWORD dst_unused:UNUSED_PAD src0_sel:WORD_0 src1_sel:DWORD
    v_add_u32_sdwa v25, v86, v4 dst_sel:DWORD dst_unused:UNUSED_PAD src0_sel:WORD_1 src1_sel:DWORD
    v_add_u32_sdwa v26, v87, v4 dst_sel:DWORD dst_unused:UNUSED_PAD src0_sel:WORD_0 src1_sel:DWORD
    v_add_u32_sdwa v27, v87, v4 dst_sel:DWORD dst_unused:UNUSED_PAD src0_sel:WORD_1 src1_sel:DWORD
    s_mov_b64 exec, 0xf
    ds_write_b64 v5, v[2:3] offset:4096
    ds_write_b64 v5, v[2:3] offset:8256
    s_mov_b64 exec, -1
    ds_read_u16 v28, v8 offset:0
    ds_read_u16 v29, v9 offset:0
    ds_read_u16 v30, v10 offset:0
    ds_read_u16 v31, v11 offset:0
    ds_read_u16 v32, v12 offset:0
    ds_read_u16 v33, v13 offset:0
    ds_read_u16 v34, v14 offset:0
    ds_read_u16 v35, v15 offset:0
    ds_read_u16 v36, v16 offset:0
    ds_read_u16 v37, v17 offset:0
    ds_read_u16 v38, v18 offset:0
    ds_read_u16 v39, v19 offset:0
    ds_read_u16 v40, v20 offset:0
    ds_read_u16 v41, v21 offset:0
    ds_read_u16 v42, v22 offset:0
    s_waitcnt lgkmcnt(10)
    v_lshl_or_b32 v68, v29, 16, v28
    v_lshl_or_b32 v69, v31, 16, v30
    v_lshl_or_b32 v70, v30, 16, v29
    v_lshl_or_b32 v71, v32, 16, v31
    ds_write_b64 v5, v[68:69] offset:3584
    ds_write_b64 v5, v[70:71] offset:7744
    ds_read_u16 v43, v18 offset:128
    ds_read_u16 v44, v19 offset:128
    ds_read_u16 v45, v20 offset:128
    ds_read_u16 v46, v21 offset:128
    ds_read_u16 v47, v22 offset:128
    s_waitcnt lgkmcnt(10)
    v_lshl_or_b32 v72, v34, 16, v33
    v_lshl_or_b32 v73, v36, 16, v35
    v_lshl_or_b32 v74, v35, 16, v34
    v_lshl_or_b32 v75, v37, 16, v36
    ds_write_b64 v5, v[72:73] offset:3072
    ds_write_b64 v5, v[74:75] offset:7232
    ds_read_u16 v48, v23 offset:0
    ds_read_u16 v49, v24 offset:0
    ds_read_u16 v50, v25 offset:0
    ds_read_u16 v51, v26 offset:0
    ds_read_u16 v52, v27 offset:0
    s_waitcnt lgkmcnt(10)
    v_lshl_or_b32 v68, v39, 16, v38
    v_lshl_or_b32 v69, v41, 16, v40
    v_lshl_or_b32 v70, v40, 16, v39
    v_lshl_or_b32 v71, v42, 16, v41
    ds_write_b64 v5, v[68:69] offset:2560
    ds_write_b64 v5, v[70:71] offset:6720
    ds_read_u16 v53, v23 offset:64
    ds_read_u16 v54, v24 offset:64
    ds_read_u16 v55, v25 offset:64
    ds_read_u16 v56, v26 offset:64
    ds_read_u16 v57, v27 offset:64
    s_waitcnt lgkmcnt(10)
    v_lshl_or_b32 v72, v44, 16, v43
    v_lshl_or_b32 v73, v46, 16, v45
    v_lshl_or_b32 v74, v45, 16, v44
    v_lshl_or_b32 v75, v47, 16, v46
    ds_write_b64 v5, v[72:73] offset:2048
    ds_write_b64 v5, v[74:75] offset:6208
    ds_read_u16 v58, v23 offset:128
    ds_read_u16 v59, v24 offset:128
    ds_read_u16 v60, v25 offset:128
    ds_read_u16 v61, v26 offset:128
    ds_read_u16 v62, v27 offset:128
    s_waitcnt lgkmcnt(10)
    v_lshl_or_b32 v68, v49, 16, v48
    v_lshl_or_b32 v69, v51, 16, v50
    v_lshl_or_b32 v70, v50, 16, v49
    v_lshl_or_b32 v71, v52, 16, v51
    ds_write_b64 v5, v[68:69] offset:1536
    ds_write_b64 v5, v[70:71] offset:5696
    ds_read_u16 v63, v23 offset:192
    ds_read_u16 v64, v24 offset:192
    ds_read_u16 v65, v25 offset:192
    ds_read_u16 v66, v26 offset:192
    ds_read_u16 v67, v27 offset:192
    s_waitcnt lgkmcnt(10)
    v_lshl_or_b32 v72, v54, 16, v53
    v_lshl_or_b32 v73, v56, 16, v55
    v_lshl_or_b32 v74, v55, 16, v54
    v_lshl_or_b32 v75, v57, 16, v56
    ds_write_b64 v5, v[72:73] offset:1024
    ds_write_b64 v5, v[74:75] offset:5184
    s_waitcnt lgkmcnt(7)
    v_lshl_or_b32 v68, v59, 16, v58
    v_lshl_or_b32 v69, v61, 16, v60
    v_lshl_or_b32 v70, v60, 16, v59
    v_lshl_or_b32 v71, v62, 16, v61
    ds_write_b64 v5, v[68:69] offset:512
    ds_write_b64 v5, v[70:71] offset:4672
    s_waitcnt lgkmcnt(2)
    v_lshl_or_b32 v72, v64, 16, v63
    v_lshl_or_b32 v73, v66, 16, v65
    v_lshl_or_b32 v74, v65, 16, v64
    v_lshl_or_b32 v75, v67, 16, v66
    ds_write_b64 v5, v[72:73] offset:0
    ds_write_b64 v5, v[74:75] offset:4160
    s_cmp_lg_u32 s3, 0
    s_cbranch_scc1 L_s_x2
    s_mov_b64 exec, 1
    global_load_dword v161, v160, s[42:43] sc0 sc1
    s_mov_b64 exec, -1
L_s_x2:
    v_and_b32 v1, 15, v0
    v_lshrrev_b32 v2, 4, v0
    v_and_b32 v3, 1, v0
    v_sub_u32 v4, v3, v1
    v_lshl_add_u32 v4, v2, 3, v4
    v_lshlrev_b32 v4, 1, v4
    v_xor_b32 v3, 1, v3
    v_mul_u32_u24 v3, 4160, v3
    s_add_u32 s13, s47, 3548
    v_add3_u32 v104, v4, v3, s13
    v_subrev_u32 v105, 1024, v104
    v_subrev_u32 v106, 2048, v104
    v_subrev_u32 v107, 3072, v104
    v_lshlrev_b32 v4, 5, v1
    v_lshl_add_u32 v109, v2, 3, v4
    v_lshrrev_b32 v109, 1, v109
    v_add_u32 v109, s47, v109
    s_mul_i32 s70, s5, 18432
    s_add_u32 s70, s70, 102144
    v_lshrrev_b32 v3, 1, v2
    v_and_b32 v4, 1, v2
    v_add3_u32 v110, v1, v3, 15
    v_lshl_add_u32 v111, v4, 8, s70
    v_lshl_add_u32 v108, v3, 8, s70
    v_lshl_add_u32 v108, v4, 3, v108
    v_lshrrev_b32 v3, 2, v1
    v_and_b32 v4, 3, v1
    v_lshl_add_u32 v152, v3, 9, v108
    v_add_u32 v3, s4, v3
    v_lshl_add_u32 v152, v4, 6, v152
    v_and_b32 v3, 3, v3
    v_lshl_add_u32 v152, v3, 4, v152
    v_lshrrev_b32 v3, 2, v110
    v_and_b32 v4, 3, v110
    v_lshl_add_u32 v108, v3, 9, v111
    v_add_u32 v3, s4, v3
    v_lshl_add_u32 v108, v4, 6, v108
    v_and_b32 v3, 3, v3
    v_lshl_add_u32 v108, v3, 4, v108
    s_mov_b32 s56, s38
    s_and_b32 s57, s39, 0xffff
    s_mov_b32 s58, 5308416
    s_mov_b32 s59, 0x20000
    v_mul_u32_u24 v6, 43, v0
    v_lshrrev_b32 v6, 8, v6
    v_mul_u32_u24 v7, 6, v6
    v_sub_u32 v7, v0, v7
    v_cmp_lt_u32 vcc, 2, v7
    v_mul_u32_u24 v6, 1152, v6
    v_lshl_add_u32 v6, v7, 7, v6
    v_add_u32 v7, 663168, v6
    v_cndmask_b32 v162, v6, v7, vcc
    v_cmp_lt_u32 vcc, 47, v0
    v_mov_b32 v6, 0x8000000
    s_lshr_b32 s13, s76, 1
    v_cndmask_b32 v162, v162, v6, vcc
    s_mul_i32 s75, s13, 1327104
    s_lshl_b32 s13, s77, 2
    s_add_u32 s13, s13, s4
    s_mul_i32 s13, s13, 9216
    s_add_u32 s75, s75, s13
    s_cmp_eq_u32 s5, 0
    s_cselect_b32 s73, 0x1fe, 0
    v_mov_b32 v8, 0
    v_mov_b32 v9, 0
    v_mov_b32 v10, 0
    v_mov_b32 v11, 0
    v_mov_b32 v12, 0
    v_mov_b32 v13, 0
    v_mov_b32 v14, 0
    v_mov_b32 v15, 0
    v_mov_b32 v16, 0
    v_mov_b32 v17, 0
    v_mov_b32 v18, 0
    v_mov_b32 v19, 0
    v_mov_b32 v20, 0
    v_mov_b32 v21, 0
    v_mov_b32 v22, 0
    v_mov_b32 v23, 0
    v_mov_b32 v24, 0
    v_mov_b32 v25, 0
    v_mov_b32 v26, 0
    v_mov_b32 v27, 0
    v_mov_b32 v28, 0
    v_mov_b32 v29, 0
    v_mov_b32 v30, 0
    v_mov_b32 v31, 0
    v_mov_b32 v32, 0
    v_mov_b32 v33, 0
    v_mov_b32 v34, 0
    v_mov_b32 v35, 0
    v_mov_b32 v36, 0
    v_mov_b32 v37, 0
    v_mov_b32 v38, 0
    v_mov_b32 v39, 0
    s_lshl_b32 s13, s68, 16
    s_and_b32 s15, s68, 0xffff0000
    s_bitcmp1_b32 s3, 0
    s_cselect_b32 s68, s15, s13
    v_mov_b32 v3, 163812
    s_cmp_lg_u32 s3, 0
    s_cbranch_scc1 L_s_spin
L_s_poll:
    s_waitcnt vmcnt(0)
    v_readfirstlane_b32 s13, v161
    s_cmp_ge_u32 s13, 43
    s_cbranch_scc1 L_s_xdma
    s_sleep 4
    s_mov_b64 exec, 1
    global_load_dword v161, v160, s[42:43] sc0 sc1
    s_mov_b64 exec, -1
    s_branch L_s_poll
L_s_xdma:
    v_mov_b32 v148, 0
    v_mov_b32 v149, 0
    v_mov_b32 v150, 0
    v_mov_b32 v151, 0
    v_lshlrev_b32 v144, 4, v0
    v_add_u32 v144, 102144, v144
    ds_write_b128 v144, v[148:151] offset:0
    ds_write_b128 v144, v[148:151] offset:1024
    ds_write_b128 v144, v[148:151] offset:18432
    ds_write_b128 v144, v[148:151] offset:19456
    ds_write_b128 v144, v[148:151] offset:36864
    ds_write_b128 v144, v[148:151] offset:37888
    v_lshrrev_b32 v144, 5, v0
    v_sub_u32 v145, v0, v144
    v_and_b32 v145, 3, v145
    v_lshlrev_b32 v144, 9, v144
    v_lshl_add_u32 v144, v145, 4, v144
    v_bfe_u32 v145, v0, 2, 2
    v_lshl_add_u32 v144, v145, 7, v144
    v_bfe_u32 v145, v0, 4, 1
    v_lshl_add_u32 v144, v145, 6, v144
    v_xor_b32 v145, 32, v144
    s_mul_i32 s13, s46, 16640
    s_add_u32 s13, s13, 26214400
    s_mov_b32 m0, 104192
    s_add_u32 s15, s13, 0
    buffer_load_dwordx4 v144, s[60:63], s15 offen offset:0 sc0 sc1 lds
    buffer_load_dwordx4 v145, s[60:63], s15 offen offset:1024 sc0 sc1 lds
    buffer_load_dwordx4 v144, s[60:63], s15 offen offset:2048 sc0 sc1 lds
    buffer_load_dwordx4 v145, s[60:63], s15 offen offset:3072 sc0 sc1 lds
    s_mov_b32 m0, 108288
    s_add_u32 s15, s13, 4096
    buffer_load_dwordx4 v144, s[60:63], s15 offen offset:0 sc0 sc1 lds
    buffer_load_dwordx4 v145, s[60:63], s15 offen offset:1024 sc0 sc1 lds
    buffer_load_dwordx4 v144, s[60:63], s15 offen offset:2048 sc0 sc1 lds
    buffer_load_dwordx4 v145, s[60:63], s15 offen offset:3072 sc0 sc1 lds
    s_mov_b32 m0, 112384
    s_add_u32 s15, s13, 8192
    buffer_load_dwordx4 v144, s[60:63], s15 offen offset:0 sc0 sc1 lds
    buffer_load_dwordx4 v145, s[60:63], s15 offen offset:1024 sc0 sc1 lds
    buffer_load_dwordx4 v144, s[60:63], s15 offen offset:2048 sc0 sc1 lds
    buffer_load_dwordx4 v145, s[60:63], s15 offen offset:3072 sc0 sc1 lds
    s_mov_b32 m0, 116480
    s_add_u32 s15, s13, 12288
    buffer_load_dwordx4 v144, s[60:63], s15 offen offset:0 sc0 sc1 lds
    buffer_load_dwordx4 v145, s[60:63], s15 offen offset:1024 sc0 sc1 lds
    buffer_load_dwordx4 v144, s[60:63], s15 offen offset:2048 sc0 sc1 lds
    buffer_load_dwordx4 v145, s[60:63], s15 offen offset:3072 sc0 sc1 lds
    s_mov_b32 m0, 122624
    s_add_u32 s15, s13, 798720
    buffer_load_dwordx4 v144, s[60:63], s15 offen offset:0 sc0 sc1 lds
    buffer_load_dwordx4 v145, s[60:63], s15 offen offset:1024 sc0 sc1 lds
    buffer_load_dwordx4 v144, s[60:63], s15 offen offset:2048 sc0 sc1 lds
    buffer_load_dwordx4 v145, s[60:63], s15 offen offset:3072 sc0 sc1 lds
    s_mov_b32 m0, 126720
    s_add_u32 s15, s13, 802816
    buffer_load_dwordx4 v144, s[60:63], s15 offen offset:0 sc0 sc1 lds
    buffer_load_dwordx4 v145, s[60:63], s15 offen offset:1024 sc0 sc1 lds
    buffer_load_dwordx4 v144, s[60:63], s15 offen offset:2048 sc0 sc1 lds
    buffer_load_dwordx4 v145, s[60:63], s15 offen offset:3072 sc0 sc1 lds
    s_mov_b32 m0, 130816
    s_add_u32 s15, s13, 806912
    buffer_load_dwordx4 v144, s[60:63], s15 offen offset:0 sc0 sc1 lds
    buffer_load_dwordx4 v145, s[60:63], s15 offen offset:1024 sc0 sc1 lds
    buffer_load_dwordx4 v144, s[60:63], s15 offen offset:2048 sc0 sc1 lds
    buffer_load_dwordx4 v145, s[60:63], s15 offen offset:3072 sc0 sc1 lds
    s_mov_b32 m0, 134912
    s_add_u32 s15, s13, 811008
    buffer_load_dwordx4 v144, s[60:63], s15 offen offset:0 sc0 sc1 lds
    buffer_load_dwordx4 v145, s[60:63], s15 offen offset:1024 sc0 sc1 lds
    buffer_load_dwordx4 v144, s[60:63], s15 offen offset:2048 sc0 sc1 lds
    buffer_load_dwordx4 v145, s[60:63], s15 offen offset:3072 sc0 sc1 lds
    s_mov_b32 m0, 141056
    s_add_u32 s15, s13, 1597440
    buffer_load_dwordx4 v144, s[60:63], s15 offen offset:0 sc0 sc1 lds
    buffer_load_dwordx4 v145, s[60:63], s15 offen offset:1024 sc0 sc1 lds
    buffer_load_dwordx4 v144, s[60:63], s15 offen offset:2048 sc0 sc1 lds
    buffer_load_dwordx4 v145, s[60:63], s15 offen offset:3072 sc0 sc1 lds
    s_mov_b32 m0, 145152
    s_add_u32 s15, s13, 1601536
    buffer_load_dwordx4 v144, s[60:63], s15 offen offset:0 sc0 sc1 lds
    buffer_load_dwordx4 v145, s[60:63], s15 offen offset:1024 sc0 sc1 lds
    buffer_load_dwordx4 v144, s[60:63], s15 offen offset:2048 sc0 sc1 lds
    buffer_load_dwordx4 v145, s[60:63], s15 offen offset:3072 sc0 sc1 lds
    s_mov_b32 m0, 149248
    s_add_u32 s15, s13, 1605632
    buffer_load_dwordx4 v144, s[60:63], s15 offen offset:0 sc0 sc1 lds
    buffer_load_dwordx4 v145, s[60:63], s15 offen offset:1024 sc0 sc1 lds
    buffer_load_dwordx4 v144, s[60:63], s15 offen offset:2048 sc0 sc1 lds
    buffer_load_dwordx4 v145, s[60:63], s15 offen offset:3072 sc0 sc1 lds
    s_mov_b32 m0, 153344
    s_add_u32 s15, s13, 1609728
    buffer_load_dwordx4 v144, s[60:63], s15 offen offset:0 sc0 sc1 lds
    buffer_load_dwordx4 v145, s[60:63], s15 offen offset:1024 sc0 sc1 lds
    buffer_load_dwordx4 v144, s[60:63], s15 offen offset:2048 sc0 sc1 lds
    buffer_load_dwordx4 v145, s[60:63], s15 offen offset:3072 sc0 sc1 lds
    v_mov_b32 v4, 1
    s_waitcnt vmcnt(32)
    ds_write_b32 v3, v4
    v_mov_b32 v4, 3
    s_waitcnt vmcnt(0)
    ds_write_b32 v3, v4
    s_branch L_s_go
L_s_spin:
    s_setprio 0
    ds_read_b32 v4, v3
    s_waitcnt lgkmcnt(0)
    v_cmp_lt_u32 vcc, s5, v4
    s_cbranch_vccz L_s_spin
L_s_go:
    s_setprio 1
    s_cmp_lg_u32 s5, 0
    s_cbranch_scc1 L_s_go2
    s_setprio 3
L_s_go2:
    s_mov_b32 s72, 221184
    s_cmp_lg_u32 s5, 0
    s_cbranch_scc1 L_s_pf0
    buffer_load_dword v163, v162, s[56:59], s75 offen
    s_add_u32 s75, s75, s72
L_s_pf0:
    ds_read_b64 v[40:41], v152 offset:2048
    ds_read_b64 v[42:43], v152 offset:4096
    ds_read_b64 v[44:45], v152 offset:6144
    ds_read_b64 v[46:47], v152 offset:8192
    ds_read_b64 v[48:49], v152 offset:10240
    ds_read_b64 v[50:51], v152 offset:12288
    ds_read_b64 v[52:53], v152 offset:14336
    ds_read_b64 v[54:55], v152 offset:16384
    s_waitcnt lgkmcnt(7)
    v_lshlrev_b32 v112, 16, v40
    v_and_b32 v113, 0xffff0000, v40
    v_lshlrev_b32 v114, 16, v41
    v_and_b32 v115, 0xffff0000, v41
    v_mul_f32 v112, s68, v112
    v_mul_f32 v113, s68, v113
    v_mul_f32 v114, s68, v114
    v_mul_f32 v115, s68, v115
    v_cvt_pk_bf16_f32 v40, v112, v113
    v_cvt_pk_bf16_f32 v41, v114, v115
    v_lshlrev_b32 v112, 16, v40
    v_and_b32 v113, 0xffff0000, v40
    v_lshlrev_b32 v114, 16, v41
    v_and_b32 v115, 0xffff0000, v41
    s_waitcnt lgkmcnt(6)
    v_lshlrev_b32 v116, 16, v42
    v_and_b32 v117, 0xffff0000, v42
    v_lshlrev_b32 v118, 16, v43
    v_and_b32 v119, 0xffff0000, v43
    v_mul_f32 v116, s68, v116
    v_mul_f32 v117, s68, v117
    v_mul_f32 v118, s68, v118
    v_mul_f32 v119, s68, v119
    v_cvt_pk_bf16_f32 v42, v116, v117
    v_cvt_pk_bf16_f32 v43, v118, v119
    v_lshlrev_b32 v116, 16, v42
    v_and_b32 v117, 0xffff0000, v42
    v_lshlrev_b32 v118, 16, v43
    v_and_b32 v119, 0xffff0000, v43
    s_waitcnt lgkmcnt(5)
    v_lshlrev_b32 v120, 16, v44
    v_and_b32 v121, 0xffff0000, v44
    v_lshlrev_b32 v122, 16, v45
    v_and_b32 v123, 0xffff0000, v45
    v_mul_f32 v120, s68, v120
    v_mul_f32 v121, s68, v121
    v_mul_f32 v122, s68, v122
    v_mul_f32 v123, s68, v123
    v_cvt_pk_bf16_f32 v44, v120, v121
    v_cvt_pk_bf16_f32 v45, v122, v123
    v_lshlrev_b32 v120, 16, v44
    v_and_b32 v121, 0xffff0000, v44
    v_lshlrev_b32 v122, 16, v45
    v_and_b32 v123, 0xffff0000, v45
    s_waitcnt lgkmcnt(4)
    v_lshlrev_b32 v124, 16, v46
    v_and_b32 v125, 0xffff0000, v46
    v_lshlrev_b32 v126, 16, v47
    v_and_b32 v127, 0xffff0000, v47
    v_mul_f32 v124, s68, v124
    v_mul_f32 v125, s68, v125
    v_mul_f32 v126, s68, v126
    v_mul_f32 v127, s68, v127
    v_cvt_pk_bf16_f32 v46, v124, v125
    v_cvt_pk_bf16_f32 v47, v126, v127
    v_lshlrev_b32 v124, 16, v46
    v_and_b32 v125, 0xffff0000, v46
    v_lshlrev_b32 v126, 16, v47
    v_and_b32 v127, 0xffff0000, v47
    s_waitcnt lgkmcnt(3)
    v_lshlrev_b32 v128, 16, v48
    v_and_b32 v129, 0xffff0000, v48
    v_lshlrev_b32 v130, 16, v49
    v_and_b32 v131, 0xffff0000, v49
    v_mul_f32 v128, s68, v128
    v_mul_f32 v129, s68, v129
    v_mul_f32 v130, s68, v130
    v_mul_f32 v131, s68, v131
    v_cvt_pk_bf16_f32 v48, v128, v129
    v_cvt_pk_bf16_f32 v49, v130, v131
    v_lshlrev_b32 v128, 16, v48
    v_and_b32 v129, 0xffff0000, v48
    v_lshlrev_b32 v130, 16, v49
    v_and_b32 v131, 0xffff0000, v49
    s_waitcnt lgkmcnt(2)
    v_lshlrev_b32 v132, 16, v50
    v_and_b32 v133, 0xffff0000, v50
    v_lshlrev_b32 v134, 16, v51
    v_and_b32 v135, 0xffff0000, v51
    v_mul_f32 v132, s68, v132
    v_mul_f32 v133, s68, v133
    v_mul_f32 v134, s68, v134
    v_mul_f32 v135, s68, v135
    v_cvt_pk_bf16_f32 v50, v132, v133
    v_cvt_pk_bf16_f32 v51, v134, v135
    v_lshlrev_b32 v132, 16, v50
    v_and_b32 v133, 0xffff0000, v50
    v_lshlrev_b32 v134, 16, v51
    v_and_b32 v135, 0xffff0000, v51
    s_waitcnt lgkmcnt(1)
    v_lshlrev_b32 v136, 16, v52
    v_and_b32 v137, 0xffff0000, v52
    v_lshlrev_b32 v138, 16, v53
    v_and_b32 v139, 0xffff0000, v53
    v_mul_f32 v136, s68, v136
    v_mul_f32 v137, s68, v137
    v_mul_f32 v138, s68, v138
    v_mul_f32 v139, s68, v139
    v_cvt_pk_bf16_f32 v52, v136, v137
    v_cvt_pk_bf16_f32 v53, v138, v139
    v_lshlrev_b32 v136, 16, v52
    v_and_b32 v137, 0xffff0000, v52
    v_lshlrev_b32 v138, 16, v53
    v_and_b32 v139, 0xffff0000, v53
    s_waitcnt lgkmcnt(0)
    v_lshlrev_b32 v140, 16, v54
    v_and_b32 v141, 0xffff0000, v54
    v_lshlrev_b32 v142, 16, v55
    v_and_b32 v143, 0xffff0000, v55
    v_mul_f32 v140, s68, v140
    v_mul_f32 v141, s68, v141
    v_mul_f32 v142, s68, v142
    v_mul_f32 v143, s68, v143
    v_cvt_pk_bf16_f32 v54, v140, v141
    v_cvt_pk_bf16_f32 v55, v142, v143
    v_lshlrev_b32 v140, 16, v54
    v_and_b32 v141, 0xffff0000, v54
    v_lshlrev_b32 v142, 16, v55
    v_and_b32 v143, 0xffff0000, v55
    s_mov_b32 s74, 8
    ds_read_b128 v[100:103], v108 offset:14336
    ds_read2_b32 v[40:41], v104 offset0:128 offset1:129
    ds_read2_b32 v[42:43], v104 offset0:130 offset1:131
    ds_read_b128 v[96:99], v108 offset:12288
    ds_read2_b32 v[44:45], v104 offset0:0 offset1:1
    ds_read2_b32 v[46:47], v104 offset0:2 offset1:3
    ds_read_b128 v[92:95], v108 offset:10240
    ds_read2_b32 v[48:49], v105 offset0:128 offset1:129
    ds_read2_b32 v[50:51], v105 offset0:130 offset1:131
    ds_read_b128 v[88:91], v108 offset:8192
    ds_read2_b32 v[52:53], v105 offset0:0 offset1:1
    ds_read2_b32 v[54:55], v105 offset0:2 offset1:3
    ds_read_b128 v[84:87], v108 offset:6144
    ds_read2_b32 v[56:57], v106 offset0:128 offset1:129
    ds_read2_b32 v[58:59], v106 offset0:130 offset1:131
    ds_read_b128 v[80:83], v108 offset:4096
    ds_read2_b32 v[60:61], v106 offset0:0 offset1:1
    ds_read2_b32 v[62:63], v106 offset0:2 offset1:3
    ds_read_b128 v[76:79], v108 offset:2048
    ds_read2_b32 v[64:65], v107 offset0:128 offset1:129
    ds_read2_b32 v[66:67], v107 offset0:130 offset1:131
    ds_read_b128 v[72:75], v108 offset:0
    ds_read2_b32 v[68:69], v107 offset0:0 offset1:1
    ds_read2_b32 v[70:71], v107 offset0:2 offset1:3
    v_subrev_u32 v110, 2, v110
    v_lshrrev_b32 v3, 2, v110
    v_and_b32 v4, 3, v110
    v_lshl_add_u32 v108, v3, 9, v111
    v_add_u32 v3, s4, v3
    v_lshl_add_u32 v108, v4, 6, v108
    v_and_b32 v3, 3, v3
    v_lshl_add_u32 v108, v3, 4, v108
    v_subrev_u32 v104, 64, v104
    v_subrev_u32 v105, 64, v105
    v_subrev_u32 v106, 64, v106
    v_subrev_u32 v107, 64, v107
.p2align 3
L_s_cl:
    s_waitcnt lgkmcnt(15)
    v_mfma_f32_16x16x32_bf16 v[36:39], v[40:43], v[100:103], v[36:39]
    ds_read_b128 v[100:103], v108 offset:14336
    v_mfma_f32_16x16x32_bf16 v[32:35], v[40:43], v[96:99], v[32:35]
    v_mfma_f32_16x16x32_bf16 v[28:31], v[40:43], v[92:95], v[28:31]
    s_waitcnt lgkmcnt(15)
    v_mfma_f32_16x16x32_bf16 v[24:27], v[40:43], v[88:91], v[24:27]
    s_waitcnt lgkmcnt(12)
    v_mfma_f32_16x16x32_bf16 v[20:23], v[40:43], v[84:87], v[20:23]
    s_waitcnt lgkmcnt(9)
    v_mfma_f32_16x16x32_bf16 v[16:19], v[40:43], v[80:83], v[16:19]
    s_waitcnt lgkmcnt(6)
    v_mfma_f32_16x16x32_bf16 v[12:15], v[40:43], v[76:79], v[12:15]
    s_waitcnt lgkmcnt(3)
    v_mfma_f32_16x16x32_bf16 v[8:11], v[40:43], v[72:75], v[8:11]
    ds_read2_b32 v[40:41], v104 offset0:128 offset1:129
    ds_read2_b32 v[42:43], v104 offset0:130 offset1:131
    v_mfma_f32_16x16x32_bf16 v[36:39], v[44:47], v[96:99], v[36:39]
    ds_read_b128 v[96:99], v108 offset:12288
    v_mfma_f32_16x16x32_bf16 v[32:35], v[44:47], v[92:95], v[32:35]
    v_mfma_f32_16x16x32_bf16 v[28:31], v[44:47], v[88:91], v[28:31]
    s_bitcmp1_b32 s73, s74
    s_cbranch_scc0 L_s_npf
    buffer_load_dword v163, v162, s[56:59], s75 offen
    s_bitcmp1_b32 0x90, s74
    s_cselect_b32 s13, -441984, s72
    s_add_u32 s75, s75, s13
L_s_npf:
    s_sub_u32 s74, s74, 1
    v_mfma_f32_16x16x32_bf16 v[24:27], v[44:47], v[84:87], v[24:27]
    v_mfma_f32_16x16x32_bf16 v[20:23], v[44:47], v[80:83], v[20:23]
    v_mfma_f32_16x16x32_bf16 v[16:19], v[44:47], v[76:79], v[16:19]
    v_mfma_f32_16x16x32_bf16 v[12:15], v[44:47], v[72:75], v[12:15]
    ds_read2_b32 v[44:45], v104 offset0:0 offset1:1
    ds_read2_b32 v[46:47], v104 offset0:2 offset1:3
    v_mfma_f32_16x16x32_bf16 v[36:39], v[48:51], v[92:95], v[36:39]
    ds_read_b128 v[92:95], v108 offset:10240
    v_mfma_f32_16x16x32_bf16 v[32:35], v[48:51], v[88:91], v[32:35]
    v_subrev_u32 v104, 64, v104
    v_subrev_u32 v110, 2, v110
    v_mfma_f32_16x16x32_bf16 v[28:31], v[48:51], v[84:87], v[28:31]
    v_lshrrev_b32 v3, 2, v110
    v_and_b32 v4, 3, v110
    v_mfma_f32_16x16x32_bf16 v[24:27], v[48:51], v[80:83], v[24:27]
    v_lshl_add_u32 v153, v3, 9, v111
    v_add_u32 v3, s4, v3
    v_mfma_f32_16x16x32_bf16 v[20:23], v[48:51], v[76:79], v[20:23]
    v_lshl_add_u32 v153, v4, 6, v153
    v_and_b32 v3, 3, v3
    v_mfma_f32_16x16x32_bf16 v[16:19], v[48:51], v[72:75], v[16:19]
    ds_read2_b32 v[48:49], v105 offset0:128 offset1:129
    ds_read2_b32 v[50:51], v105 offset0:130 offset1:131
    v_mfma_f32_16x16x32_bf16 v[36:39], v[52:55], v[88:91], v[36:39]
    ds_read_b128 v[88:91], v108 offset:8192
    v_mfma_f32_16x16x32_bf16 v[32:35], v[52:55], v[84:87], v[32:35]
    v_lshl_add_u32 v153, v3, 4, v153
    v_mfma_f32_16x16x32_bf16 v[28:31], v[52:55], v[80:83], v[28:31]
    v_mfma_f32_16x16x32_bf16 v[24:27], v[52:55], v[76:79], v[24:27]
    v_mfma_f32_16x16x32_bf16 v[20:23], v[52:55], v[72:75], v[20:23]
    ds_read2_b32 v[52:53], v105 offset0:0 offset1:1
    ds_read2_b32 v[54:55], v105 offset0:2 offset1:3
    v_mfma_f32_16x16x32_bf16 v[36:39], v[56:59], v[84:87], v[36:39]
    ds_read_b128 v[84:87], v108 offset:6144
    v_mfma_f32_16x16x32_bf16 v[32:35], v[56:59], v[80:83], v[32:35]
    v_subrev_u32 v105, 64, v105
    v_mfma_f32_16x16x32_bf16 v[28:31], v[56:59], v[76:79], v[28:31]
    v_mfma_f32_16x16x32_bf16 v[24:27], v[56:59], v[72:75], v[24:27]
    ds_read2_b32 v[56:57], v106 offset0:128 offset1:129
    ds_read2_b32 v[58:59], v106 offset0:130 offset1:131
    v_mfma_f32_16x16x32_bf16 v[36:39], v[60:63], v[80:83], v[36:39]
    ds_read_b128 v[80:83], v108 offset:4096
    v_mfma_f32_16x16x32_bf16 v[32:35], v[60:63], v[76:79], v[32:35]
    v_mfma_f32_16x16x32_bf16 v[28:31], v[60:63], v[72:75], v[28:31]
    ds_read2_b32 v[60:61], v106 offset0:0 offset1:1
    ds_read2_b32 v[62:63], v106 offset0:2 offset1:3
    v_mfma_f32_16x16x32_bf16 v[36:39], v[64:67], v[76:79], v[36:39]
    ds_read_b128 v[76:79], v108 offset:2048
    v_subrev_u32 v106, 64, v106
    v_mfma_f32_16x16x32_bf16 v[32:35], v[64:67], v[72:75], v[32:35]
    ds_read2_b32 v[64:65], v107 offset0:128 offset1:129
    ds_read2_b32 v[66:67], v107 offset0:130 offset1:131
    s_waitcnt lgkmcnt(15)
    v_mfma_f32_16x16x32_bf16 v[36:39], v[68:71], v[72:75], v[36:39]
    ds_read_b128 v[72:75], v108 offset:0
    ds_read2_b32 v[68:69], v107 offset0:0 offset1:1
    ds_read2_b32 v[70:71], v107 offset0:2 offset1:3
    s_cmp_lg_u32 s74, 0
    v_mov_b32 v108, v153
    v_subrev_u32 v107, 64, v107
    s_cbranch_scc1 L_s_cl
    s_setprio 3
    v_bfe_u32 v3, v0, 2, 2
    v_mul_u32_u24 v3, 8512, v3
    v_and_b32 v4, 3, v0
    v_lshl_add_u32 v3, v4, 3, v3
    v_lshl_add_u32 v3, v2, 5, v3
    s_mul_i32 s13, s5, 34048
    s_lshl_b32 s15, s4, 9
    s_add_u32 s13, s13, s15
    v_add_u32 v3, s13, v3
    v_lshlrev_b32 v4, 4, v0
    s_mul_i32 s13, s69, 16384
    s_lshl_b32 s15, s15, 3
    s_add_u32 s13, s13, s15
    s_add_u32 s13, s13, 20971520
    v_cvt_pk_bf16_f32 v8, v8, v9
    v_cvt_pk_bf16_f32 v9, v10, v11
    v_cvt_pk_bf16_f32 v12, v12, v13
    v_cvt_pk_bf16_f32 v13, v14, v15
    v_cvt_pk_bf16_f32 v16, v16, v17
    v_cvt_pk_bf16_f32 v17, v18, v19
    v_cvt_pk_bf16_f32 v20, v20, v21
    v_cvt_pk_bf16_f32 v21, v22, v23
    v_cvt_pk_bf16_f32 v24, v24, v25
    v_cvt_pk_bf16_f32 v25, v26, v27
    v_cvt_pk_bf16_f32 v28, v28, v29
    v_cvt_pk_bf16_f32 v29, v30, v31
    v_cvt_pk_bf16_f32 v32, v32, v33
    v_cvt_pk_bf16_f32 v33, v34, v35
    v_cvt_pk_bf16_f32 v36, v36, v37
    v_cvt_pk_bf16_f32 v37, v38, v39
    v_and_b32 v11, 0xffff0000, v9
    v_lshlrev_b32 v10, 16, v9
    v_and_b32 v9, 0xffff0000, v8
    v_lshlrev_b32 v8, 16, v8
    v_add_f32 v112, v8, v112
    v_add_f32 v113, v9, v113
    v_add_f32 v114, v10, v114
    v_add_f32 v115, v11, v115
    v_and_b32 v15, 0xffff0000, v13
    v_lshlrev_b32 v14, 16, v13
    v_and_b32 v13, 0xffff0000, v12
    v_lshlrev_b32 v12, 16, v12
    v_add_f32 v116, v12, v116
    v_add_f32 v117, v13, v117
    v_add_f32 v118, v14, v118
    v_add_f32 v119, v15, v119
    v_cvt_pk_bf16_f32 v8, v112, v114
    v_cvt_pk_bf16_f32 v9, v113, v115
    ds_write2st64_b32 v109, v8, v9 offset0:0 offset1:8
    v_and_b32 v19, 0xffff0000, v17
    v_lshlrev_b32 v18, 16, v17
    v_and_b32 v17, 0xffff0000, v16
    v_lshlrev_b32 v16, 16, v16
    v_add_f32 v120, v16, v120
    v_add_f32 v121, v17, v121
    v_add_f32 v122, v18, v122
    v_add_f32 v123, v19, v123
    v_cvt_pk_bf16_f32 v12, v116, v118
    v_cvt_pk_bf16_f32 v13, v117, v119
    ds_write2st64_b32 v109, v12, v13 offset0:1 offset1:9
    v_and_b32 v23, 0xffff0000, v21
    v_lshlrev_b32 v22, 16, v21
    v_and_b32 v21, 0xffff0000, v20
    v_lshlrev_b32 v20, 16, v20
    v_add_f32 v124, v20, v124
    v_add_f32 v125, v21, v125
    v_add_f32 v126, v22, v126
    v_add_f32 v127, v23, v127
    v_cvt_pk_bf16_f32 v16, v120, v122
    v_cvt_pk_bf16_f32 v17, v121, v123
    ds_write2st64_b32 v109, v16, v17 offset0:2 offset1:10
    v_and_b32 v27, 0xffff0000, v25
    v_lshlrev_b32 v26, 16, v25
    v_and_b32 v25, 0xffff0000, v24
    v_lshlrev_b32 v24, 16, v24
    v_add_f32 v128, v24, v128
    v_add_f32 v129, v25, v129
    v_add_f32 v130, v26, v130
    v_add_f32 v131, v27, v131
    v_cvt_pk_bf16_f32 v20, v124, v126
    v_cvt_pk_bf16_f32 v21, v125, v127
    ds_write2st64_b32 v109, v20, v21 offset0:3 offset1:11
    v_and_b32 v31, 0xffff0000, v29
    v_lshlrev_b32 v30, 16, v29
    v_and_b32 v29, 0xffff0000, v28
    v_lshlrev_b32 v28, 16, v28
    v_add_f32 v132, v28, v132
    v_add_f32 v133, v29, v133
    v_add_f32 v134, v30, v134
    v_add_f32 v135, v31, v135
    v_cvt_pk_bf16_f32 v24, v128, v130
    v_cvt_pk_bf16_f32 v25, v129, v131
    ds_write2st64_b32 v109, v24, v25 offset0:4 offset1:12
    v_and_b32 v35, 0xffff0000, v33
    v_lshlrev_b32 v34, 16, v33
    v_and_b32 v33, 0xffff0000, v32
    v_lshlrev_b32 v32, 16, v32
    v_add_f32 v136, v32, v136
    v_add_f32 v137, v33, v137
    v_add_f32 v138, v34, v138
    v_add_f32 v139, v35, v139
    v_cvt_pk_bf16_f32 v28, v132, v134
    v_cvt_pk_bf16_f32 v29, v133, v135
    ds_write2st64_b32 v109, v28, v29 offset0:5 offset1:13
    v_and_b32 v39, 0xffff0000, v37
    v_lshlrev_b32 v38, 16, v37
    v_and_b32 v37, 0xffff0000, v36
    v_lshlrev_b32 v36, 16, v36
    v_add_f32 v140, v36, v140
    v_add_f32 v141, v37, v141
    v_add_f32 v142, v38, v142
    v_add_f32 v143, v39, v143
    v_cvt_pk_bf16_f32 v32, v136, v138
    v_cvt_pk_bf16_f32 v33, v137, v139
    ds_write2st64_b32 v109, v32, v33 offset0:6 offset1:14
    v_cvt_pk_bf16_f32 v36, v140, v142
    v_cvt_pk_bf16_f32 v37, v141, v143
    ds_write2st64_b32 v109, v36, v37 offset0:7 offset1:15
    s_lshl_b32 s12, s5, 3
    s_add_u32 s12, s12, 163816
    v_mov_b32 v1, s12
    v_mov_b32 v5, 1
    s_mov_b64 exec, 1
    ds_add_u32 v1, v5
    s_mov_b64 exec, -1
    s_setprio 3
L_s_g4:
    s_sleep 1
    ds_read_b32 v6, v1
    s_waitcnt lgkmcnt(0)
    v_cmp_gt_u32 vcc, 4, v6
    s_cbranch_vccnz L_s_g4
    ds_read_b64_tr_b16 v[8:9], v3 offset:0
    ds_read_b64_tr_b16 v[10:11], v3 offset:2048
    ds_read_b64_tr_b16 v[12:13], v3 offset:128
    ds_read_b64_tr_b16 v[14:15], v3 offset:2176
    ds_read_b64_tr_b16 v[16:17], v3 offset:256
    ds_read_b64_tr_b16 v[18:19], v3 offset:2304
    ds_read_b64_tr_b16 v[20:21], v3 offset:384
    ds_read_b64_tr_b16 v[22:23], v3 offset:2432
    s_waitcnt lgkmcnt(6)
    buffer_store_dwordx4 v[8:11], v4, s[60:63], s13 offen offset:0 sc0 sc1
    s_waitcnt lgkmcnt(4)
    buffer_store_dwordx4 v[12:15], v4, s[60:63], s13 offen offset:1024 sc0 sc1
    s_waitcnt lgkmcnt(2)
    buffer_store_dwordx4 v[16:19], v4, s[60:63], s13 offen offset:2048 sc0 sc1
    s_waitcnt lgkmcnt(0)
    buffer_store_dwordx4 v[20:23], v4, s[60:63], s13 offen offset:3072 sc0 sc1
    s_lshr_b32 s13, s46, 3
    s_and_b32 s12, s46, 7
    s_bfe_u32 s10, s46, 0x20002
    s_and_b32 s11, s46, 3
    s_add_u32 s11, s11, 8
    s_cmp_lt_u32 s46, 32
    s_cselect_b32 s13, s13, s10
    s_cselect_b32 s12, s12, s11
    s_lshl2_add_u32 s13, s5, s13
    s_mul_i32 s13, s13, 128
    s_lshl_b32 s12, s12, 2
    s_add_u32 s13, s13, s12
    s_add_u32 s13, s13, 29360160
    v_mul_u32_u24 v3, 1536, v0
    s_mov_b64 exec, 1
    s_waitcnt vmcnt(0)
    ds_add_rtn_u32 v2, v1, v5 offset:4
    s_waitcnt lgkmcnt(0)
    v_readfirstlane_b32 s12, v2
    s_cmp_eq_u32 s12, 3
    s_cselect_b32 exec_lo, 0x3ffffff, 0
    buffer_store_dword v5, v3, s[60:63], s13 offen sc0 sc1
    s_mov_b64 exec, -1
    s_endpgm
L_exitA:
    s_endpgm
.p2align 4
.type L_xtab,@object
L_xtab:
.short 510, 478, 446, 414, 382, 768, 766, 734
.short 382, 350, 318, 286, 508, 734, 702, 670
.short 508, 476, 444, 412, 380, 670, 764, 732
.short 380, 348, 316, 284, 506, 732, 700, 668
.short 506, 474, 442, 410, 378, 668, 762, 730
.short 378, 346, 314, 282, 504, 730, 698, 666
.short 504, 472, 440, 408, 376, 666, 760, 728
.short 376, 344, 312, 280, 502, 728, 696, 664
.short 502, 470, 438, 406, 374, 664, 758, 726
.short 374, 342, 310, 278, 500, 726, 694, 662
.short 500, 468, 436, 404, 372, 662, 756, 724
.short 372, 340, 308, 276, 498, 724, 692, 660
.short 498, 466, 434, 402, 370, 660, 754, 722
.short 370, 338, 306, 274, 496, 722, 690, 658
.short 496, 464, 432, 400, 368, 658, 752, 720
.short 368, 336, 304, 272, 494, 720, 688, 656
.short 494, 462, 430, 398, 366, 656, 750, 718
.short 366, 334, 302, 270, 492, 718, 686, 654
.short 492, 460, 428, 396, 364, 654, 748, 716
.short 364, 332, 300, 268, 490, 716, 684, 652
.short 490, 458, 426, 394, 362, 652, 746, 714
.short 362, 330, 298, 266, 488, 714, 682, 650
.short 488, 456, 424, 392, 360, 650, 744, 712
.short 360, 328, 296, 264, 486, 712, 680, 648
.short 486, 454, 422, 390, 358, 648, 742, 710
.short 358, 326, 294, 262, 484, 710, 678, 646
.short 484, 452, 420, 388, 356, 646, 740, 708
.short 356, 324, 292, 260, 482, 708, 676, 644
.short 482, 450, 418, 386, 354, 644, 738, 706
.short 354, 322, 290, 258, 480, 706, 674, 642
.short 480, 448, 416, 384, 352, 642, 736, 704
.short 352, 320, 288, 256, 254, 704, 672, 640
.short 254, 222, 190, 158, 126, 640, 638, 606
.short 126, 94, 62, 30, 252, 606, 574, 542
.short 252, 220, 188, 156, 124, 542, 636, 604
.short 124, 92, 60, 28, 250, 604, 572, 540
.short 250, 218, 186, 154, 122, 540, 634, 602
.short 122, 90, 58, 26, 248, 602, 570, 538
.short 248, 216, 184, 152, 120, 538, 632, 600
.short 120, 88, 56, 24, 246, 600, 568, 536
.short 246, 214, 182, 150, 118, 536, 630, 598
.short 118, 86, 54, 22, 244, 598, 566, 534
.short 244, 212, 180, 148, 116, 534, 628, 596
.short 116, 84, 52, 20, 242, 596, 564, 532
.short 242, 210, 178, 146, 114, 532, 626, 594
.short 114, 82, 50, 18, 240, 594, 562, 530
.short 240, 208, 176, 144, 112, 530, 624, 592
.short 112, 80, 48, 16, 238, 592, 560, 528
.short 238, 206, 174, 142, 110, 528, 622, 590
.short 110, 78, 46, 14, 236, 590, 558, 526
.short 236, 204, 172, 140, 108, 526, 620, 588
.short 108, 76, 44, 12, 234, 588, 556, 524
.short 234, 202, 170, 138, 106, 524, 618, 586
.short 106, 74, 42, 10, 232, 586, 554, 522
.short 232, 200, 168, 136, 104, 522, 616, 584
.short 104, 72, 40, 8, 230, 584, 552, 520
.short 230, 198, 166, 134, 102, 520, 614, 582
.short 102, 70, 38, 6, 228, 582, 550, 518
.short 228, 196, 164, 132, 100, 518, 612, 580
.short 100, 68, 36, 4, 226, 580, 548, 516
.short 226, 194, 162, 130, 98, 516, 610, 578
.short 98, 66, 34, 2, 224, 578, 546, 514
.short 224, 192, 160, 128, 96, 514, 608, 576
.short 96, 64, 32, 0, 1504, 576, 544, 512
.short 734, 734, 896, 896, 894, 894, 894, 1088
.short 670, 670, 894, 862, 862, 862, 862, 1086
.short 732, 732, 862, 862, 892, 892, 892, 1086
.short 668, 668, 892, 860, 860, 860, 860, 1084
.short 730, 730, 860, 860, 890, 890, 890, 1084
.short 666, 666, 890, 858, 858, 858, 858, 1082
.short 728, 728, 858, 858, 888, 888, 888, 1082
.short 664, 664, 888, 856, 856, 856, 856, 1080
.short 726, 726, 856, 856, 886, 886, 886, 1080
.short 662, 662, 886, 854, 854, 854, 854, 1078
.short 724, 724, 854, 854, 884, 884, 884, 1078
.short 660, 660, 884, 852, 852, 852, 852, 1076
.short 722, 722, 852, 852, 882, 882, 882, 1076
.short 658, 658, 882, 850, 850, 850, 850, 1074
.short 720, 720, 850, 850, 880, 880, 880, 1074
.short 656, 656, 880, 848, 848, 848, 848, 1072
.short 718, 718, 848, 848, 878, 878, 878, 1072
.short 654, 654, 878, 846, 846, 846, 846, 1070
.short 716, 716, 846, 846, 876, 876, 876, 1070
.short 652, 652, 876, 844, 844, 844, 844, 1068
.short 714, 714, 844, 844, 874, 874, 874, 1068
.short 650, 650, 874, 842, 842, 842, 842, 1066
.short 712, 712, 842, 842, 872, 872, 872, 1066
.short 648, 648, 872, 840, 840, 840, 840, 1064
.short 710, 710, 840, 840, 870, 870, 870, 1064
.short 646, 646, 870, 838, 838, 838, 838, 1062
.short 708, 708, 838, 838, 868, 868, 868, 1062
.short 644, 644, 868, 836, 836, 836, 836, 1060
.short 706, 706, 836, 836, 866, 866, 866, 1060
.short 642, 642, 866, 834, 834, 834, 834, 1058
.short 704, 704, 834, 834, 864, 864, 864, 1058
.short 640, 640, 864, 832, 832, 832, 832, 1056
.short 606, 606, 832, 832, 830, 830, 830, 1056
.short 542, 542, 830, 798, 798, 798, 798, 1054
.short 604, 604, 798, 798, 828, 828, 828, 1054
.short 540, 540, 828, 796, 796, 796, 796, 1052
.short 602, 602, 796, 796, 826, 826, 826, 1052
.short 538, 538, 826, 794, 794, 794, 794, 1050
.short 600, 600, 794, 794, 824, 824, 824, 1050
.short 536, 536, 824, 792, 792, 792, 792, 1048
.short 598, 598, 792, 792, 822, 822, 822, 1048
.short 534, 534, 822, 790, 790, 790, 790, 1046
.short 596, 596, 790, 790, 820, 820, 820, 1046
.short 532, 532, 820, 788, 788, 788, 788, 1044
.short 594, 594, 788, 788, 818, 818, 818, 1044
.short 530, 530, 818, 786, 786, 786, 786, 1042
.short 592, 592, 786, 786, 816, 816, 816, 1042
.short 528, 528, 816, 784, 784, 784, 784, 1040
.short 590, 590, 784, 784, 814, 814, 814, 1040
.short 526, 526, 814, 782, 782, 782, 782, 1038
.short 588, 588, 782, 782, 812, 812, 812, 1038
.short 524, 524, 812, 780, 780, 780, 780, 1036
.short 586, 586, 780, 780, 810, 810, 810, 1036
.short 522, 522, 810, 778, 778, 778, 778, 1034
.short 584, 584, 778, 778, 808, 808, 808, 1034
.short 520, 520, 808, 776, 776, 776, 776, 1032
.short 582, 582, 776, 776, 806, 806, 806, 1032
.short 518, 518, 806, 774, 774, 774, 774, 1030
.short 580, 580, 774, 774, 804, 804, 804, 1030
.short 516, 516, 804, 772, 772, 772, 772, 1028
.short 578, 578, 772, 772, 802, 802, 802, 1028
.short 514, 514, 802, 770, 770, 770, 770, 1026
.short 576, 576, 770, 770, 800, 800, 800, 1026
.short 512, 510, 800, 768, 768, 768, 768, 1024
.short 1088, 1088, 1088, 1086
.short 1086, 1086, 1086, 1086
.short 1086, 1086, 1084, 1084
.short 1084, 1084, 1084, 1084
.short 1084, 1084, 1084, 1082
.short 1082, 1082, 1082, 1082
.short 1082, 1082, 1080, 1080
.short 1080, 1080, 1080, 1080
.short 1080, 1080, 1080, 1078
.short 1078, 1078, 1078, 1078
.short 1078, 1078, 1076, 1076
.short 1076, 1076, 1076, 1076
.short 1076, 1076, 1076, 1074
.short 1074, 1074, 1074, 1074
.short 1074, 1074, 1072, 1072
.short 1072, 1072, 1072, 1072
.short 1072, 1072, 1072, 1070
.short 1070, 1070, 1070, 1070
.short 1070, 1070, 1068, 1068
.short 1068, 1068, 1068, 1068
.short 1068, 1068, 1068, 1066
.short 1066, 1066, 1066, 1066
.short 1066, 1066, 1064, 1064
.short 1064, 1064, 1064, 1064
.short 1064, 1064, 1064, 1062
.short 1062, 1062, 1062, 1062
.short 1062, 1062, 1060, 1060
.short 1060, 1060, 1060, 1060
.short 1060, 1060, 1060, 1058
.short 1058, 1058, 1058, 1058
.short 1058, 1058, 1056, 1056
.short 1056, 1056, 1056, 1056
.short 1056, 1056, 1056, 1054
.short 1054, 1054, 1054, 1054
.short 1054, 1054, 1052, 1052
.short 1052, 1052, 1052, 1052
.short 1052, 1052, 1052, 1050
.short 1050, 1050, 1050, 1050
.short 1050, 1050, 1048, 1048
.short 1048, 1048, 1048, 1048
.short 1048, 1048, 1048, 1046
.short 1046, 1046, 1046, 1046
.short 1046, 1046, 1044, 1044
.short 1044, 1044, 1044, 1044
.short 1044, 1044, 1044, 1042
.short 1042, 1042, 1042, 1042
.short 1042, 1042, 1040, 1040
.short 1040, 1040, 1040, 1040
.short 1040, 1040, 1040, 1038
.short 1038, 1038, 1038, 1038
.short 1038, 1038, 1036, 1036
.short 1036, 1036, 1036, 1036
.short 1036, 1036, 1036, 1034
.short 1034, 1034, 1034, 1034
.short 1034, 1034, 1032, 1032
.short 1032, 1032, 1032, 1032
.short 1032, 1032, 1032, 1030
.short 1030, 1030, 1030, 1030
.short 1030, 1030, 1028, 1028
.short 1028, 1028, 1028, 1028
.short 1028, 1028, 1028, 1026
.short 1026, 1026, 1026, 1026
.short 1026, 1026, 1024, 1024
.short 1024, 1024, 1024, 1024
.size L_xtab, 2560
.p2align 2
L_code_end:
    s_endpgm
.section .rodata,"a"
.p2align 6
.amdhsa_kernel parallel_sum__ssm_conv_s4__dense_activation_relu__prompt_kernel
  .amdhsa_next_free_vgpr 168
  .amdhsa_next_free_sgpr 102
  .amdhsa_accum_offset 168
  .amdhsa_group_segment_fixed_size 0
  .amdhsa_kernarg_size 120
  .amdhsa_user_sgpr_count 2
  .amdhsa_user_sgpr_kernarg_segment_ptr 1
  .amdhsa_system_sgpr_workgroup_id_x 1
  .amdhsa_float_denorm_mode_32 3
.end_amdhsa_kernel
```
